```python
import torch

def _softmax(x, axis=-1):
    return torch.softmax(x, dim=axis)
def _gelu(x):
    return torch.nn.functional.gelu(x, approximate="tanh")
def _silu(x):
    return torch.nn.functional.silu(x)
def _sigmoid(x):
    return torch.sigmoid(x)
def _layernorm(x, axis=-1, eps=1e-5):
    m = x.mean(dim=axis, keepdim=True)
    v = x.var(dim=axis, keepdim=True, unbiased=False)
    return (x - m) / torch.sqrt(v + eps)
def _scatter_add(tgt, idx, src, axis=0):
    return tgt.clone().index_add_(axis, idx, src)
def _segment_sum(src, seg, n):
    out = torch.zeros((n,) + src.shape[1:], dtype=src.dtype)
    return out.index_add_(0, seg, src)
def _pad(x, pw):
    flat = tuple(v for pair in reversed(pw) for v in pair)
    return torch.nn.functional.pad(x, flat)

kernel_name = 'interleave_layers__ssm_conv_h3__dense_activation_relu__prompt'

def setup_inputs():

    _w = (lambda a: (lambda t: t.to(torch.bfloat16) if t.is_floating_point() else t)(torch.as_tensor(a)))
    def _A_setup():
        B, S, D = 1, 2048, 448
        ks = 4
        return {
            "q": _w((lambda *s: torch.randn(*s, dtype=torch.bfloat16) * 0.05)(B, S, D)),
            "k": _w((lambda *s: torch.randn(*s, dtype=torch.bfloat16) * 0.8)(B, S, D)),
            "v": _w((lambda *s: torch.randn(*s, dtype=torch.bfloat16) * 0.8)(B, S, D)),
            "shift_k": _w((lambda *s: torch.randn(*s, dtype=torch.bfloat16) * 0.8)(D, ks) * 0.5),
            "ssm_k": _w((lambda *s: torch.randn(*s, dtype=torch.bfloat16) * 0.8)(D, S) * (1.0 / S ** 0.5)),
            "ssm_D": _w((lambda *s: torch.randn(*s, dtype=torch.bfloat16) * 0.8)(D)),
        }
    _A_in = _A_setup()

    def _B_setup():
        B, S, D, Dff = 1, 2048, 448, 1792
        return {
            "x": _w((lambda *s: torch.randn(*s, dtype=torch.bfloat16) * 0.05)(B, S, D)),
            "w1": _w((lambda *s: torch.randn(*s, dtype=torch.bfloat16) * 0.1)(D, Dff)),
            "w2": _w((lambda *s: torch.randn(*s, dtype=torch.bfloat16) * 0.1)(Dff, D)),
        }
    _B_in = _B_setup()

    return {
        "A_q": _A_in["q"],
        "A_k": _A_in["k"],
        "A_v": _A_in["v"],
        "A_shift_k": _A_in["shift_k"],
        "A_ssm_k": _A_in["ssm_k"],
        "A_ssm_D": _A_in["ssm_D"],
        "B_x": _B_in["x"],
        "B_w1": _B_in["w1"],
        "B_w2": _B_in["w2"],
    }

def reference(A_q, A_k, A_v, A_shift_k, A_ssm_k, A_ssm_D, B_x, B_w1, B_w2):
    def _A_ref(q, k, v, shift_k, ssm_k, ssm_D):
        B, S, D = q.shape
        ks = shift_k.shape[-1]
        k_pad = _pad(k, ((0, 0), (ks - 1, 0), (0, 0)))
        k_shift = torch.zeros_like(k)
        for t in range(ks):
            k_shift = k_shift + k_pad[:, t:t + S, :] * shift_k[:, ks - 1 - t][None, None, :]
        kv = k_shift * v
        L = 2 * S
        kv_pad = _pad(kv, ((0, 0), (0, S), (0, 0)))
        kf_pad = _pad(ssm_k, ((0, 0), (0, S)))
        kv_f = (lambda x, axes=(-2,-1): torch.fft.rfft2(x.float(), dim=axes))(kv_pad[:, None, :, :], axes=(1, 2))
        kf_f = (lambda x, axes=(-2,-1): torch.fft.rfft2(x.float(), dim=axes))(kf_pad[:, None, :], axes=(1, 2))
        kf_f = (lambda x, *d: x.permute(*d))(kf_f, 1, 2, 0)
        y_f = kv_f * kf_f[None, :, :, :]
        y = (lambda x, s, axes=(-2,-1): torch.fft.irfft2(x, s=s, dim=axes).to(torch.bfloat16))(y_f, (1, L), axes=(1, 2))[:, 0, :S, :]
        y = y + kv * ssm_D[None, None, :]
        return q * y

    def _B_ref(x, w1, w2):
        h = torch.einsum("bsd,df->bsf", x, w1)
        zero = torch.zeros_like(h)
        h = torch.maximum(h, zero)
        return torch.einsum("bsf,fd->bsd", h, w2)

    x = A_q
    x = x + _A_ref(_layernorm(x, axis=-1), A_k, A_v, A_shift_k, A_ssm_k, A_ssm_D)
    x = x + _B_ref(_layernorm(x, axis=-1), B_w1, B_w2)
    x = x + _A_ref(_layernorm(x, axis=-1), A_k, A_v, A_shift_k, A_ssm_k, A_ssm_D)
    x = x + _B_ref(_layernorm(x, axis=-1), B_w1, B_w2)
    return x
```

```asm
; @launch grid=(256,1,1) block=(256,1,1) lds=163840
.amdgcn_target "amdgcn-amd-amdhsa--gfx950"
.text
.globl interleave_layers__ssm_conv_h3__dense_activation_relu__prompt_kernel
.p2align 8
.type interleave_layers__ssm_conv_h3__dense_activation_relu__prompt_kernel,@function
interleave_layers__ssm_conv_h3__dense_activation_relu__prompt_kernel:
  s_cmp_ge_u32 s2, 256
  s_cbranch_scc1 L_end
  s_load_dwordx16 s[16:31], s[0:1], 0
  s_load_dwordx8 s[32:39], s[0:1], 64
  v_lshrrev_b32 v1, 6, v0
  v_and_b32 v0, 63, v0
  s_getpc_b64 s[80:81]
  v_readfirstlane_b32 s3, v1
  s_mov_b32 s12, 0xffff0000
  s_and_b32 s6, s2, 7
  s_lshr_b32 s7, s2, 3
  s_lshl_b32 s4, s6, 1
  s_lshr_b32 s6, s7, 4
  s_add_u32 s4, s4, s6
  s_and_b32 s5, s7, 15
  s_mov_b32 s82, L_end-interleave_layers__ssm_conv_h3__dense_activation_relu__prompt_kernel-64
  s_mov_b32 s83, 0x20000
  s_lshl_b32 s7, s7, 2
  s_add_u32 s7, s7, s3
  s_lshl_b32 s7, s7, 10
  v_lshlrev_b32 v2, 4, v0
  buffer_load_dword v254, v2, s[80:83], s7 offen
  s_getreg_b32 s68, hwreg(HW_REG_XCC_ID)
  s_and_b32 s68, s68, 7
  s_lshl_b32 s71, s4, 8
  s_add_u32 s71, s71, 37748736
  s_lshl_b32 s66, s4, 4
  s_add_u32 s66, s66, s5
  s_lshl_b32 s6, s5, 2
  s_add_u32 s6, s6, s3
  s_lshl_b32 s6, s6, 2
  v_mov_b32 v1, 0x7ffffff0
  v_mov_b32 v2, s6
  v_cmp_eq_u32 vcc, 0, v0
  s_lshl_b32 s6, s4, 7
  s_nop 0
  v_cndmask_b32 v246, v1, v2, vcc
  s_lshl_b32 s7, s5, 3
  s_add_u32 s6, s6, s7
  s_lshl_b32 s7, s3, 1
  s_add_u32 s7, s7, s6
  s_mul_i32 s7, s7, 896
  v_cmp_gt_u32 vcc, 56, v0
  v_lshl_add_u32 v200, v0, 4, s7
  s_nop 0
  v_cndmask_b32 v200, v1, v200, vcc
  v_cndmask_b32 v201, 0, 1.0, vcc
  s_lshl_b32 s8, s4, 3
  s_lshr_b32 s9, s5, 1
  s_add_u32 s8, s8, s9
  s_mul_i32 s8, s8, 14336
  s_and_b32 s9, s5, 1
  s_lshl_b32 s9, s9, 7
  s_add_u32 s8, s8, s9
  s_lshl_b32 s9, s3, 5
  s_add_u32 s8, s8, s9
  v_lshl_add_u32 v5, v0, 8, s8
  v_cndmask_b32 v247, v1, v5, vcc
  s_waitcnt lgkmcnt(0)
  s_mov_b32 s40, s38
  s_mov_b32 s41, s39
  s_mov_b32 s42, 0x2500000
  s_mov_b32 s43, 0x20000
  s_mov_b32 s72, s36
  s_mov_b32 s73, s37
  s_mov_b32 s74, 0x100
  s_mov_b32 s75, 0x20000
  s_or_b32 s6, s2, s3
  s_cmp_lg_u32 s6, 0
  s_cbranch_scc1 L_nn_1
  s_memrealtime s[78:79]
  v_lshlrev_b32 v242, 12, v0
  s_waitcnt lgkmcnt(0)
  s_or_b32 s78, s78, 8
  s_and_b32 s78, s78, -8
  v_mov_b32 v243, s78
  buffer_store_dword v243, v242, s[72:75], 0 offen sc1
L_nn_1:
  s_and_b32 s6, s2, 7
  s_cmp_eq_u32 s6, 7
  s_cbranch_scc1 L_pathB_2
  s_mov_b32 s44, s18
  s_mov_b32 s45, s19
  s_mov_b32 s46, 0x1c0000
  s_mov_b32 s47, 0x20000
  s_mov_b32 s48, s20
  s_mov_b32 s49, s21
  s_mov_b32 s50, 0x1c0000
  s_mov_b32 s51, 0x20000
  s_mov_b32 s52, s22
  s_mov_b32 s53, s23
  s_mov_b32 s54, 0xe00
  s_mov_b32 s55, 0x20000
  v_lshrrev_b32 v2, 5, v0
  v_lshl_add_u32 v2, s3, 1, v2
  v_and_b32 v5, 31, v0
  s_lshr_b32 s6, s2, 3
  s_and_b32 s7, s2, 7
  s_lshl_b32 s7, s7, 6
  s_lshl_b32 s8, s6, 3
  v_add_u32 v12, s8, v2
  v_lshl_add_u32 v13, v5, 1, s7
  v_mul_u32_u24 v6, 7168, v12
  v_lshl_add_u32 v6, v13, 1, v6
  v_subrev_u32 v7, 2688, v6
  v_add_u32 v8, 3584, v6
  v_lshlrev_b32 v9, 3, v13
  buffer_load_dword v20, v7, s[44:47], 0 offen offset:0
  buffer_load_dword v21, v7, s[44:47], 0 offen offset:896
  buffer_load_dword v22, v7, s[44:47], 0 offen offset:1792
  buffer_load_dword v23, v6, s[44:47], 0 offen offset:0
  buffer_load_dword v24, v6, s[44:47], 0 offen offset:896
  buffer_load_dword v25, v6, s[44:47], 0 offen offset:1792
  buffer_load_dword v26, v6, s[44:47], 0 offen offset:2688
  buffer_load_dword v27, v8, s[44:47], 0 offen offset:0
  buffer_load_dword v28, v8, s[44:47], 0 offen offset:896
  buffer_load_dword v29, v8, s[44:47], 0 offen offset:1792
  buffer_load_dword v30, v8, s[44:47], 0 offen offset:2688
  buffer_load_dwordx4 v[40:43], v9, s[52:55], 0 offen
  buffer_load_dword v32, v6, s[48:51], 0 offen offset:0
  buffer_load_dword v33, v6, s[48:51], 0 offen offset:896
  buffer_load_dword v34, v6, s[48:51], 0 offen offset:1792
  buffer_load_dword v35, v6, s[48:51], 0 offen offset:2688
  buffer_load_dword v36, v8, s[48:51], 0 offen offset:0
  buffer_load_dword v37, v8, s[48:51], 0 offen offset:896
  buffer_load_dword v38, v8, s[48:51], 0 offen offset:1792
  buffer_load_dword v39, v8, s[48:51], 0 offen offset:2688
  v_mul_u32_u24 v3, 272, v5
  v_lshl_add_u32 v3, v2, 4, v3
  v_add_u32 v3, 75008, v3
  v_lshrrev_b32 v4, 4, v0
  v_mul_u32_u24 v4, 272, v4
  v_and_b32 v12, 15, v0
  v_lshl_add_u32 v4, v12, 4, v4
  v_add_u32 v4, 75008, v4
  v_lshrrev_b32 v10, 3, v0
  v_add_u32 v10, s7, v10
  v_lshlrev_b32 v10, 12, v10
  v_and_b32 v12, 7, v0
  v_add_u32 v12, s8, v12
  v_lshl_add_u32 v10, v12, 4, v10
  v_add_u32 v11, s7, v0
  v_lshlrev_b32 v11, 12, v11
  s_lshl_b32 s8, s8, 4
  v_add_u32 v11, s8, v11
  s_cmp_eq_u32 s3, 1
  s_cselect_b32 s91, 0, 0x7ffffff0
  s_lshr_b32 s6, s3, 1
  s_and_b32 s88, s3, 1
  s_lshl_b32 s8, s66, 1
  s_add_u32 s8, s8, s6
  s_lshl_b32 s89, s8, 12
  s_add_u32 s80, s24, s89
  s_addc_u32 s81, s25, 0
  s_mov_b32 s82, 0x1000
  s_mov_b32 s83, 0x20000
  s_mov_b32 s84, s26
  s_mov_b32 s85, s27
  s_mov_b32 s86, 0x380
  s_mov_b32 s87, 0x20000
  s_mul_i32 s90, s6, 39936
  s_add_u32 s90, s90, 83968
  v_lshl_add_u32 v12, s88, 6, v0
  v_lshlrev_b32 v108, 5, v12
  v_subrev_u32 v13, 16, v108
  buffer_load_dwordx4 v[120:123], v13, s[80:83], 0 offen
  buffer_load_dwordx4 v[124:127], v108, s[80:83], 0 offen
  buffer_load_dwordx4 v[128:131], v108, s[80:83], 0 offen offset:16
  s_lshl_b32 s8, s8, 1
  v_mov_b32 v13, s8
  buffer_load_ushort v109, v13, s[84:87], 0 offen
  v_lshrrev_b32 v13, 2, v12
  v_mul_u32_u24 v13, 144, v13
  v_and_b32 v14, 3, v12
  v_lshl_add_u32 v13, v14, 5, v13
  v_add_u32 v116, s90, v13
  v_add_u32 v117, s90, v108
  s_waitcnt vmcnt(12)
  v_mov_b32 v242, 0
  s_cmp_lg_u32 s3, 0
  s_cbranch_scc1 L_gn_4
  buffer_load_dword v243, v242, s[72:75], 0 offen sc1
L_gn_4:
  s_cmp_eq_u32 s3, 0
  s_cbranch_scc1 L_nw0_5
  buffer_load_dword v254, v11, s[40:43], s91 offen sc1
L_nw0_5:
  v_lshlrev_b32 v44, 16, v20
  v_and_b32 v45, s12, v20
  v_lshlrev_b32 v46, 16, v21
  v_and_b32 v47, s12, v21
  v_lshlrev_b32 v48, 16, v22
  v_and_b32 v49, s12, v22
  v_lshlrev_b32 v50, 16, v23
  v_and_b32 v51, s12, v23
  v_lshlrev_b32 v52, 16, v24
  v_and_b32 v53, s12, v24
  v_lshlrev_b32 v54, 16, v25
  v_and_b32 v55, s12, v25
  v_lshlrev_b32 v56, 16, v26
  v_and_b32 v57, s12, v26
  v_lshlrev_b32 v58, 16, v27
  v_and_b32 v59, s12, v27
  v_lshlrev_b32 v60, 16, v28
  v_and_b32 v61, s12, v28
  v_lshlrev_b32 v62, 16, v29
  v_and_b32 v63, s12, v29
  v_lshlrev_b32 v64, 16, v30
  v_and_b32 v65, s12, v30
  v_lshlrev_b32 v66, 16, v40
  v_lshlrev_b32 v67, 16, v42
  v_and_b32 v68, s12, v40
  v_and_b32 v69, s12, v42
  v_lshlrev_b32 v70, 16, v41
  v_lshlrev_b32 v71, 16, v43
  v_and_b32 v72, s12, v41
  v_and_b32 v73, s12, v43
  v_pk_mul_f32 v[74:75], v[44:45], v[72:73]
  v_pk_mul_f32 v[76:77], v[46:47], v[70:71]
  v_pk_mul_f32 v[78:79], v[48:49], v[68:69]
  v_pk_mul_f32 v[80:81], v[50:51], v[66:67]
  v_pk_mul_f32 v[82:83], v[46:47], v[72:73]
  v_pk_mul_f32 v[84:85], v[48:49], v[70:71]
  v_pk_mul_f32 v[86:87], v[50:51], v[68:69]
  v_pk_mul_f32 v[88:89], v[52:53], v[66:67]
  v_cvt_pk_bf16_f32 v74, v74, v75
  v_and_b32 v75, s12, v74
  v_lshlrev_b32 v74, 16, v74
  v_cvt_pk_bf16_f32 v82, v82, v83
  v_and_b32 v83, s12, v82
  v_lshlrev_b32 v82, 16, v82
  v_cvt_pk_bf16_f32 v76, v76, v77
  v_and_b32 v77, s12, v76
  v_lshlrev_b32 v76, 16, v76
  v_cvt_pk_bf16_f32 v84, v84, v85
  v_and_b32 v85, s12, v84
  v_lshlrev_b32 v84, 16, v84
  v_cvt_pk_bf16_f32 v78, v78, v79
  v_and_b32 v79, s12, v78
  v_lshlrev_b32 v78, 16, v78
  v_cvt_pk_bf16_f32 v86, v86, v87
  v_and_b32 v87, s12, v86
  v_lshlrev_b32 v86, 16, v86
  v_cvt_pk_bf16_f32 v80, v80, v81
  v_and_b32 v81, s12, v80
  v_lshlrev_b32 v80, 16, v80
  v_cvt_pk_bf16_f32 v88, v88, v89
  v_and_b32 v89, s12, v88
  v_lshlrev_b32 v88, 16, v88
  v_pk_add_f32 v[74:75], v[74:75], v[76:77]
  v_pk_add_f32 v[82:83], v[82:83], v[84:85]
  v_cvt_pk_bf16_f32 v74, v74, v75
  v_and_b32 v75, s12, v74
  v_lshlrev_b32 v74, 16, v74
  v_cvt_pk_bf16_f32 v82, v82, v83
  v_and_b32 v83, s12, v82
  v_lshlrev_b32 v82, 16, v82
  v_pk_add_f32 v[74:75], v[74:75], v[78:79]
  v_pk_add_f32 v[82:83], v[82:83], v[86:87]
  v_cvt_pk_bf16_f32 v74, v74, v75
  v_and_b32 v75, s12, v74
  v_lshlrev_b32 v74, 16, v74
  v_cvt_pk_bf16_f32 v82, v82, v83
  v_and_b32 v83, s12, v82
  v_lshlrev_b32 v82, 16, v82
  v_pk_add_f32 v[74:75], v[74:75], v[80:81]
  v_pk_add_f32 v[82:83], v[82:83], v[88:89]
  v_cvt_pk_bf16_f32 v74, v74, v75
  v_and_b32 v75, s12, v74
  v_lshlrev_b32 v74, 16, v74
  v_cvt_pk_bf16_f32 v82, v82, v83
  v_and_b32 v83, s12, v82
  v_lshlrev_b32 v82, 16, v82
  s_waitcnt vmcnt(5)
  v_lshlrev_b32 v76, 16, v32
  v_and_b32 v77, s12, v32
  v_lshlrev_b32 v84, 16, v33
  v_and_b32 v85, s12, v33
  v_pk_mul_f32 v[74:75], v[74:75], v[76:77]
  v_pk_mul_f32 v[82:83], v[82:83], v[84:85]
  v_cvt_pk_bf16_f32 v90, v74, v75
  v_cvt_pk_bf16_f32 v91, v82, v83
  v_pk_mul_f32 v[74:75], v[48:49], v[72:73]
  v_pk_mul_f32 v[76:77], v[50:51], v[70:71]
  v_pk_mul_f32 v[78:79], v[52:53], v[68:69]
  v_pk_mul_f32 v[80:81], v[54:55], v[66:67]
  v_pk_mul_f32 v[82:83], v[50:51], v[72:73]
  v_pk_mul_f32 v[84:85], v[52:53], v[70:71]
  v_pk_mul_f32 v[86:87], v[54:55], v[68:69]
  v_pk_mul_f32 v[88:89], v[56:57], v[66:67]
  v_cvt_pk_bf16_f32 v74, v74, v75
  v_and_b32 v75, s12, v74
  v_lshlrev_b32 v74, 16, v74
  v_cvt_pk_bf16_f32 v82, v82, v83
  v_and_b32 v83, s12, v82
  v_lshlrev_b32 v82, 16, v82
  v_cvt_pk_bf16_f32 v76, v76, v77
  v_and_b32 v77, s12, v76
  v_lshlrev_b32 v76, 16, v76
  v_cvt_pk_bf16_f32 v84, v84, v85
  v_and_b32 v85, s12, v84
  v_lshlrev_b32 v84, 16, v84
  v_cvt_pk_bf16_f32 v78, v78, v79
  v_and_b32 v79, s12, v78
  v_lshlrev_b32 v78, 16, v78
  v_cvt_pk_bf16_f32 v86, v86, v87
  v_and_b32 v87, s12, v86
  v_lshlrev_b32 v86, 16, v86
  v_cvt_pk_bf16_f32 v80, v80, v81
  v_and_b32 v81, s12, v80
  v_lshlrev_b32 v80, 16, v80
  v_cvt_pk_bf16_f32 v88, v88, v89
  v_and_b32 v89, s12, v88
  v_lshlrev_b32 v88, 16, v88
  v_pk_add_f32 v[74:75], v[74:75], v[76:77]
  v_pk_add_f32 v[82:83], v[82:83], v[84:85]
  v_cvt_pk_bf16_f32 v74, v74, v75
  v_and_b32 v75, s12, v74
  v_lshlrev_b32 v74, 16, v74
  v_cvt_pk_bf16_f32 v82, v82, v83
  v_and_b32 v83, s12, v82
  v_lshlrev_b32 v82, 16, v82
  v_pk_add_f32 v[74:75], v[74:75], v[78:79]
  v_pk_add_f32 v[82:83], v[82:83], v[86:87]
  v_cvt_pk_bf16_f32 v74, v74, v75
  v_and_b32 v75, s12, v74
  v_lshlrev_b32 v74, 16, v74
  v_cvt_pk_bf16_f32 v82, v82, v83
  v_and_b32 v83, s12, v82
  v_lshlrev_b32 v82, 16, v82
  v_pk_add_f32 v[74:75], v[74:75], v[80:81]
  v_pk_add_f32 v[82:83], v[82:83], v[88:89]
  v_cvt_pk_bf16_f32 v74, v74, v75
  v_and_b32 v75, s12, v74
  v_lshlrev_b32 v74, 16, v74
  v_cvt_pk_bf16_f32 v82, v82, v83
  v_and_b32 v83, s12, v82
  v_lshlrev_b32 v82, 16, v82
  v_lshlrev_b32 v76, 16, v34
  v_and_b32 v77, s12, v34
  v_lshlrev_b32 v84, 16, v35
  v_and_b32 v85, s12, v35
  v_pk_mul_f32 v[74:75], v[74:75], v[76:77]
  v_pk_mul_f32 v[82:83], v[82:83], v[84:85]
  v_cvt_pk_bf16_f32 v92, v74, v75
  v_cvt_pk_bf16_f32 v93, v82, v83
  v_pk_mul_f32 v[74:75], v[52:53], v[72:73]
  v_pk_mul_f32 v[76:77], v[54:55], v[70:71]
  v_pk_mul_f32 v[78:79], v[56:57], v[68:69]
  v_pk_mul_f32 v[80:81], v[58:59], v[66:67]
  v_pk_mul_f32 v[82:83], v[54:55], v[72:73]
  v_pk_mul_f32 v[84:85], v[56:57], v[70:71]
  v_pk_mul_f32 v[86:87], v[58:59], v[68:69]
  v_pk_mul_f32 v[88:89], v[60:61], v[66:67]
  v_cvt_pk_bf16_f32 v74, v74, v75
  v_and_b32 v75, s12, v74
  v_lshlrev_b32 v74, 16, v74
  v_cvt_pk_bf16_f32 v82, v82, v83
  v_and_b32 v83, s12, v82
  v_lshlrev_b32 v82, 16, v82
  v_cvt_pk_bf16_f32 v76, v76, v77
  v_and_b32 v77, s12, v76
  v_lshlrev_b32 v76, 16, v76
  v_cvt_pk_bf16_f32 v84, v84, v85
  v_and_b32 v85, s12, v84
  v_lshlrev_b32 v84, 16, v84
  v_cvt_pk_bf16_f32 v78, v78, v79
  v_and_b32 v79, s12, v78
  v_lshlrev_b32 v78, 16, v78
  v_cvt_pk_bf16_f32 v86, v86, v87
  v_and_b32 v87, s12, v86
  v_lshlrev_b32 v86, 16, v86
  v_cvt_pk_bf16_f32 v80, v80, v81
  v_and_b32 v81, s12, v80
  v_lshlrev_b32 v80, 16, v80
  v_cvt_pk_bf16_f32 v88, v88, v89
  v_and_b32 v89, s12, v88
  v_lshlrev_b32 v88, 16, v88
  v_pk_add_f32 v[74:75], v[74:75], v[76:77]
  v_pk_add_f32 v[82:83], v[82:83], v[84:85]
  v_cvt_pk_bf16_f32 v74, v74, v75
  v_and_b32 v75, s12, v74
  v_lshlrev_b32 v74, 16, v74
  v_cvt_pk_bf16_f32 v82, v82, v83
  v_and_b32 v83, s12, v82
  v_lshlrev_b32 v82, 16, v82
  v_pk_add_f32 v[74:75], v[74:75], v[78:79]
  v_pk_add_f32 v[82:83], v[82:83], v[86:87]
  v_cvt_pk_bf16_f32 v74, v74, v75
  v_and_b32 v75, s12, v74
  v_lshlrev_b32 v74, 16, v74
  v_cvt_pk_bf16_f32 v82, v82, v83
  v_and_b32 v83, s12, v82
  v_lshlrev_b32 v82, 16, v82
  v_pk_add_f32 v[74:75], v[74:75], v[80:81]
  v_pk_add_f32 v[82:83], v[82:83], v[88:89]
  v_cvt_pk_bf16_f32 v74, v74, v75
  v_and_b32 v75, s12, v74
  v_lshlrev_b32 v74, 16, v74
  v_cvt_pk_bf16_f32 v82, v82, v83
  v_and_b32 v83, s12, v82
  v_lshlrev_b32 v82, 16, v82
  s_cmp_lg_u32 s3, 0
  s_cbranch_scc1 L_gn_6
  s_mov_b32 s77, 0
  s_branch L_pchk_9
L_poll_7:
  buffer_load_dword v243, v242, s[72:75], 0 offen sc1
L_pchk_9:
  s_add_u32 s77, s77, 1
  s_waitcnt vmcnt(0)
  v_cmp_eq_u32 vcc, 0, v243
  s_cmp_ge_u32 s77, 400000
  s_cbranch_scc1 L_pdone_8
  s_cbranch_vccnz L_poll_7
L_pdone_8:
  v_readfirstlane_b32 s70, v243
  s_lshl_b32 s76, s4, 4
  s_add_u32 s76, s76, s5
  s_lshl_b32 s76, s76, 4
  s_add_u32 s76, s76, 37801984
  v_or_b32 v243, s68, v243
  v_cmp_eq_u32 vcc, 0, v0
  v_mov_b32 v244, 0x7ffffff0
  s_nop 0
  v_cndmask_b32 v242, v244, 0, vcc
  buffer_store_dword v243, v242, s[40:43], s76 offen sc1
  v_mov_b32 v244, 83712
  v_mov_b32 v248, 0
  v_mov_b32 v249, s70
  ds_write_b64 v244, v[248:249]
L_gn_6:
  v_lshlrev_b32 v76, 16, v36
  v_and_b32 v77, s12, v36
  v_lshlrev_b32 v84, 16, v37
  v_and_b32 v85, s12, v37
  v_pk_mul_f32 v[74:75], v[74:75], v[76:77]
  v_pk_mul_f32 v[82:83], v[82:83], v[84:85]
  v_cvt_pk_bf16_f32 v94, v74, v75
  v_cvt_pk_bf16_f32 v95, v82, v83
  v_pk_mul_f32 v[74:75], v[56:57], v[72:73]
  v_pk_mul_f32 v[76:77], v[58:59], v[70:71]
  v_pk_mul_f32 v[78:79], v[60:61], v[68:69]
  v_pk_mul_f32 v[80:81], v[62:63], v[66:67]
  v_pk_mul_f32 v[82:83], v[58:59], v[72:73]
  v_pk_mul_f32 v[84:85], v[60:61], v[70:71]
  v_pk_mul_f32 v[86:87], v[62:63], v[68:69]
  v_pk_mul_f32 v[88:89], v[64:65], v[66:67]
  v_cvt_pk_bf16_f32 v74, v74, v75
  v_and_b32 v75, s12, v74
  v_lshlrev_b32 v74, 16, v74
  v_cvt_pk_bf16_f32 v82, v82, v83
  v_and_b32 v83, s12, v82
  v_lshlrev_b32 v82, 16, v82
  v_cvt_pk_bf16_f32 v76, v76, v77
  v_and_b32 v77, s12, v76
  v_lshlrev_b32 v76, 16, v76
  v_cvt_pk_bf16_f32 v84, v84, v85
  v_and_b32 v85, s12, v84
  v_lshlrev_b32 v84, 16, v84
  v_cvt_pk_bf16_f32 v78, v78, v79
  v_and_b32 v79, s12, v78
  v_lshlrev_b32 v78, 16, v78
  v_cvt_pk_bf16_f32 v86, v86, v87
  v_and_b32 v87, s12, v86
  v_lshlrev_b32 v86, 16, v86
  v_cvt_pk_bf16_f32 v80, v80, v81
  v_and_b32 v81, s12, v80
  v_lshlrev_b32 v80, 16, v80
  v_cvt_pk_bf16_f32 v88, v88, v89
  v_and_b32 v89, s12, v88
  v_lshlrev_b32 v88, 16, v88
  v_pk_add_f32 v[74:75], v[74:75], v[76:77]
  v_pk_add_f32 v[82:83], v[82:83], v[84:85]
  v_cvt_pk_bf16_f32 v74, v74, v75
  v_and_b32 v75, s12, v74
  v_lshlrev_b32 v74, 16, v74
  v_cvt_pk_bf16_f32 v82, v82, v83
  v_and_b32 v83, s12, v82
  v_lshlrev_b32 v82, 16, v82
  v_pk_add_f32 v[74:75], v[74:75], v[78:79]
  v_pk_add_f32 v[82:83], v[82:83], v[86:87]
  v_cvt_pk_bf16_f32 v74, v74, v75
  v_and_b32 v75, s12, v74
  v_lshlrev_b32 v74, 16, v74
  v_cvt_pk_bf16_f32 v82, v82, v83
  v_and_b32 v83, s12, v82
  v_lshlrev_b32 v82, 16, v82
  v_pk_add_f32 v[74:75], v[74:75], v[80:81]
  v_pk_add_f32 v[82:83], v[82:83], v[88:89]
  v_cvt_pk_bf16_f32 v74, v74, v75
  v_and_b32 v75, s12, v74
  v_lshlrev_b32 v74, 16, v74
  v_cvt_pk_bf16_f32 v82, v82, v83
  v_and_b32 v83, s12, v82
  v_lshlrev_b32 v82, 16, v82
  v_lshlrev_b32 v76, 16, v38
  v_and_b32 v77, s12, v38
  v_lshlrev_b32 v84, 16, v39
  v_and_b32 v85, s12, v39
  v_pk_mul_f32 v[74:75], v[74:75], v[76:77]
  v_pk_mul_f32 v[82:83], v[82:83], v[84:85]
  v_cvt_pk_bf16_f32 v96, v74, v75
  v_cvt_pk_bf16_f32 v97, v82, v83
  s_mov_b32 s6, 0x05040100
  s_mov_b32 s7, 0x07060302
  v_perm_b32 v100, v96, v97, s6
  v_perm_b32 v104, v96, v97, s7
  v_perm_b32 v101, v94, v95, s6
  v_perm_b32 v105, v94, v95, s7
  v_perm_b32 v102, v92, v93, s6
  v_perm_b32 v106, v92, v93, s7
  v_perm_b32 v103, v90, v91, s6
  v_perm_b32 v107, v90, v91, s7
  ds_write_b128 v3, v[100:103]
  ds_write_b128 v3, v[104:107] offset:128
  s_cmp_eq_u32 s3, 0
  s_cbranch_scc1 L_vw_10
  s_waitcnt vmcnt(1)
L_vw_10:
  v_mov_b32 v40, 0
  v_mov_b32 v41, 0
  v_mov_b32 v42, 0
  v_mov_b32 v43, 0
  v_lshrrev_b32 v6, 3, v0
  v_subrev_u32 v8, 1, v6
  v_subrev_u32 v7, 4, v6
  v_cmp_lt_u32 vcc, 4, v6
  s_nop 1
  v_cndmask_b32 v8, v8, v7, vcc
  v_lshlrev_b32 v8, 6, v8
  v_add_u32 v8, 16, v8
  v_cmp_eq_u32 vcc, 0, v6
  s_nop 1
  v_cndmask_b32 v8, v8, 0, vcc
  v_mul_u32_u24 v7, 4352, v6
  v_add_u32 v7, v7, v8
  v_and_b32 v8, 7, v0
  v_lshl_add_u32 v7, v8, 4, v7
  v_add_u32 v7, s90, v7
  v_lshl_add_u32 v9, v8, 4, s90
  s_cmp_lg_u32 s88, 0
  s_cbranch_scc1 L_noz_11
  ds_write_b128 v7, v[40:43]
  ds_write_b128 v9, v[40:43] offset:35072
L_noz_11:
  v_mov_b32 v44, v121
  v_mov_b32 v45, v122
  v_mov_b32 v46, v123
  v_mov_b32 v47, v124
  v_mov_b32 v48, v125
  v_mov_b32 v49, v126
  v_mov_b32 v50, v127
  v_mov_b32 v51, v128
  v_mov_b32 v52, v129
  v_mov_b32 v53, v130
  v_alignbit_b32 v54, v121, v120, 16
  v_alignbit_b32 v55, v122, v121, 16
  v_alignbit_b32 v56, v123, v122, 16
  v_alignbit_b32 v57, v124, v123, 16
  v_alignbit_b32 v58, v125, v124, 16
  v_alignbit_b32 v59, v126, v125, 16
  v_alignbit_b32 v60, v127, v126, 16
  v_alignbit_b32 v61, v128, v127, 16
  v_alignbit_b32 v62, v129, v128, 16
  v_alignbit_b32 v63, v130, v129, 16
  v_alignbit_b32 v64, v131, v130, 16
  v_alignbit_b32 v66, v122, v121, 16
  v_alignbit_b32 v67, v123, v122, 16
  v_alignbit_b32 v68, v124, v123, 16
  v_alignbit_b32 v69, v125, v124, 16
  v_alignbit_b32 v70, v126, v125, 16
  v_alignbit_b32 v71, v127, v126, 16
  v_alignbit_b32 v72, v128, v127, 16
  v_alignbit_b32 v73, v129, v128, 16
  v_alignbit_b32 v74, v130, v129, 16
  v_alignbit_b32 v75, v131, v130, 16
  ds_write_b128 v117, v[120:123] offset:112
  ds_write_b128 v117, v[124:127] offset:128
  ds_write_b128 v117, v[54:57] offset:4480
  ds_write_b128 v117, v[58:61] offset:4496
  ds_write_b128 v117, v[44:47] offset:8896
  ds_write_b128 v117, v[48:51] offset:8912
  ds_write_b128 v117, v[66:69] offset:13312
  ds_write_b128 v117, v[70:73] offset:13328
  ds_write_b128 v117, v[122:125] offset:17728
  ds_write_b128 v117, v[126:129] offset:17744
  ds_write_b128 v117, v[56:59] offset:21952
  ds_write_b128 v117, v[60:63] offset:21968
  ds_write_b128 v117, v[46:49] offset:26368
  ds_write_b128 v117, v[50:53] offset:26384
  ds_write_b128 v117, v[68:71] offset:30784
  ds_write_b128 v117, v[72:75] offset:30800
  ds_write_b128 v117, v[128:131] offset:144
  v_lshlrev_b32 v109, 16, v109
  v_and_b32 v114, 31, v0
  v_lshrrev_b32 v115, 5, v0
  v_add_u32 v8, 1, v114
  v_and_b32 v9, 7, v8
  v_subrev_u32 v13, 1, v9
  v_subrev_u32 v110, 4, v9
  v_cmp_lt_u32 vcc, 4, v9
  s_nop 1
  v_cndmask_b32 v13, v13, v110, vcc
  v_lshlrev_b32 v13, 6, v13
  v_add_u32 v13, 16, v13
  v_cmp_eq_u32 vcc, 0, v9
  s_nop 1
  v_cndmask_b32 v13, v13, 0, vcc
  v_mul_u32_u24 v110, 4352, v9
  v_add_u32 v110, v110, v13
  v_lshrrev_b32 v8, 3, v8
  v_sub_u32 v8, v8, v115
  v_lshl_add_u32 v110, v8, 4, v110
  s_mul_i32 s13, s88, 1536
  s_add_u32 s13, s13, s90
  s_add_u32 s13, s13, 16
  v_add_u32 v110, s13, v110
  v_lshl_add_u32 v111, v115, 4, s90
  v_add_u32 v111, 35072, v111
  s_mul_i32 s13, s88, 12
  v_subrev_u32 v112, s13, v114
  v_add_u32 v112, 1, v112
  v_mul_i32_i24 v112, 144, v112
  v_add_u32 v112, v112, v111
  s_waitcnt lgkmcnt(0)
  s_barrier
  v_mov_b32 v244, 83712
  ds_read_b64 v[248:249], v244
  s_waitcnt lgkmcnt(0)
  v_readfirstlane_b32 s67, v248
  v_readfirstlane_b32 s70, v249
  v_mov_b32 v245, v249
  s_mul_i32 s6, s3, 2176
  v_add_u32 v12, s6, v4
  ds_read_b128 v[16:19], v12 offset:0
  ds_read_b128 v[20:23], v12 offset:1088
  s_lshl_b32 s8, s3, 16
  s_add_u32 s9, s8, 32768
  s_lshl_b32 s76, s66, 2
  s_add_u32 s76, s76, s3
  s_lshl_b32 s76, s76, 2
  s_add_u32 s76, s76, 37785600
  s_waitcnt lgkmcnt(1)
  buffer_store_dwordx4 v[16:19], v10, s[40:43], s8 offen
  s_waitcnt lgkmcnt(0)
  buffer_store_dwordx4 v[20:23], v10, s[40:43], s9 offen
  v_cmp_eq_u32 vcc, 0, v0
  v_mov_b32 v244, 0x7ffffff0
  v_or_b32 v243, s68, v245
  v_cndmask_b32 v244, v244, 0, vcc
  s_waitcnt vmcnt(0)
  buffer_store_dword v243, v244, s[40:43], s76 offen
  s_cmp_lg_u32 s3, 0
  s_cbranch_scc1 L_w0_12
  s_and_b32 s6, s2, 7
  s_lshr_b32 s7, s2, 6
  v_and_b32 v252, 31, v0
  v_lshl_add_u32 v252, s6, 5, v252
  v_lshl_add_u32 v253, v252, 2, s7
  v_lshlrev_b32 v253, 2, v253
  v_add_u32 v253, 37785600, v253
  v_lshlrev_b32 v252, 2, v252
  v_add_u32 v252, 37797888, v252
  v_cmp_gt_u32 vcc, 32, v0
  v_or_b32 v244, s68, v245
  s_nop 0
  v_cndmask_b32 v242, v252, v253, vcc
  v_cndmask_b32 v252, v245, v244, vcc
  s_mov_b32 s77, 0
L_poll_14:
  buffer_load_dword v243, v242, s[40:43], 0 offen sc1
  s_add_u32 s77, s77, 1
  s_waitcnt vmcnt(0)
  v_cmp_ne_u32 vcc, v252, v243
  s_nop 1
  s_and_b32 s7, vcc_lo, vcc_hi
  s_cmp_eq_u32 s7, 0
  s_cbranch_scc1 L_pdone_15
  s_cmp_lg_u32 s77, 40
  s_cbranch_scc1 L_p1_16
  ds_read_b128 v[16:19], v4 offset:0
  ds_read_b128 v[20:23], v4 offset:1088
  ds_read_b128 v[24:27], v4 offset:2176
  ds_read_b128 v[28:31], v4 offset:3264
  ds_read_b128 v[32:35], v4 offset:4352
  ds_read_b128 v[36:39], v4 offset:5440
  ds_read_b128 v[40:43], v4 offset:6528
  ds_read_b128 v[44:47], v4 offset:7616
  s_mov_b32 s8, 0
  s_waitcnt lgkmcnt(7)
  buffer_store_dwordx4 v[16:19], v10, s[40:43], s8 offen sc1
  s_mov_b32 s8, 32768
  s_waitcnt lgkmcnt(6)
  buffer_store_dwordx4 v[20:23], v10, s[40:43], s8 offen sc1
  s_mov_b32 s8, 65536
  s_waitcnt lgkmcnt(5)
  buffer_store_dwordx4 v[24:27], v10, s[40:43], s8 offen sc1
  s_mov_b32 s8, 98304
  s_waitcnt lgkmcnt(4)
  buffer_store_dwordx4 v[28:31], v10, s[40:43], s8 offen sc1
  s_mov_b32 s8, 131072
  s_waitcnt lgkmcnt(3)
  buffer_store_dwordx4 v[32:35], v10, s[40:43], s8 offen sc1
  s_mov_b32 s8, 163840
  s_waitcnt lgkmcnt(2)
  buffer_store_dwordx4 v[36:39], v10, s[40:43], s8 offen sc1
  s_mov_b32 s8, 196608
  s_waitcnt lgkmcnt(1)
  buffer_store_dwordx4 v[40:43], v10, s[40:43], s8 offen sc1
  s_mov_b32 s8, 229376
  s_waitcnt lgkmcnt(0)
  buffer_store_dwordx4 v[44:47], v10, s[40:43], s8 offen sc1
  s_lshl_b32 s76, s66, 2
  s_add_u32 s76, s76, 37797888
  v_cmp_eq_u32 vcc, 0, v0
  v_mov_b32 v244, 0x7ffffff0
  v_or_b32 v243, s68, v245
  v_cndmask_b32 v244, v244, 0, vcc
  s_waitcnt vmcnt(0)
  buffer_store_dword v245, v244, s[40:43], s76 offen sc1
L_p1_16:
  s_cmp_lt_u32 s77, 400000
  s_cbranch_scc1 L_poll_14
L_pdone_15:
L_w0_12:
  s_sub_u32 s92, s3, 1
  s_lshl_b32 s92, s92, 10
  s_mul_i32 s94, s5, 100352
  s_add_u32 s94, s94, 33554432
  s_add_u32 s94, s94, s92
  v_lshlrev_b32 v119, 4, v0
  s_cmp_lg_u32 s3, 0
  s_cbranch_scc1 L_w0_17
  s_add_u32 s11, s89, 0
  s_add_u32 s13, s11, 4096
  buffer_load_dwordx4 v[16:19], v119, s[40:43], s11 offen offset:0 sc1
  buffer_load_dwordx4 v[20:23], v119, s[40:43], s11 offen offset:1024 sc1
  buffer_load_dwordx4 v[24:27], v119, s[40:43], s11 offen offset:2048 sc1
  buffer_load_dwordx4 v[28:31], v119, s[40:43], s11 offen offset:3072 sc1
  buffer_load_dwordx4 v[32:35], v119, s[40:43], s13 offen offset:0 sc1
  buffer_load_dwordx4 v[36:39], v119, s[40:43], s13 offen offset:1024 sc1
  buffer_load_dwordx4 v[40:43], v119, s[40:43], s13 offen offset:2048 sc1
  buffer_load_dwordx4 v[44:47], v119, s[40:43], s13 offen offset:3072 sc1
  v_lshrrev_b32 v12, 3, v0
  v_mul_u32_u24 v12, 144, v12
  v_and_b32 v13, 7, v0
  v_lshl_add_u32 v12, v13, 4, v12
  v_add_u32 v12, 119184, v12
  s_waitcnt vmcnt(7)
  ds_write_b128 v12, v[16:19] offset:0
  s_waitcnt vmcnt(6)
  ds_write_b128 v12, v[20:23] offset:1152
  s_waitcnt vmcnt(5)
  ds_write_b128 v12, v[24:27] offset:2304
  s_waitcnt vmcnt(4)
  ds_write_b128 v12, v[28:31] offset:3456
  s_waitcnt vmcnt(3)
  ds_write_b128 v12, v[32:35] offset:39936
  s_waitcnt vmcnt(2)
  ds_write_b128 v12, v[36:39] offset:41088
  s_waitcnt vmcnt(1)
  ds_write_b128 v12, v[40:43] offset:42240
  s_waitcnt vmcnt(0)
  ds_write_b128 v12, v[44:47] offset:43392
L_w0_17:
  s_mov_b32 s52, s16
  s_mov_b32 s53, s17
  s_mov_b32 s54, 0x1c0000
  s_mov_b32 s55, 0x20000
  buffer_load_dwordx4 v[192:195], v200, s[52:55], 0 offen
  buffer_load_dwordx4 v[196:199], v200, s[52:55], 0 offen offset:896
  s_waitcnt lgkmcnt(0)
  s_barrier
  s_cmp_lg_u32 s88, 0
  s_cbranch_scc1 L_chi_18
  ds_read_b128 v[136:139], v110 offset:32
  ds_read_b128 v[140:143], v110 offset:0
  v_max_i32 v113, v112, v111
  v_subrev_u32 v112, 144, v112
  ds_read_b128 v[160:163], v113
  ds_read_b128 v[120:123], v110 offset:160
  ds_read_b128 v[144:147], v110 offset:96
  ds_read_b128 v[164:167], v113 offset:32
  ds_read_b128 v[124:127], v110 offset:128
  ds_read_b128 v[148:151], v110 offset:64
  ds_read_b128 v[168:171], v113 offset:64
  ds_read_b128 v[172:175], v113 offset:96
  v_max_i32 v113, v112, v111
  v_subrev_u32 v112, 144, v112
  ds_read_b128 v[176:179], v113
  ds_read_b128 v[128:131], v110 offset:288
  ds_read_b128 v[152:155], v110 offset:224
  ds_read_b128 v[180:183], v113 offset:32
  ds_read_b128 v[132:135], v110 offset:256
  ds_read_b128 v[156:159], v110 offset:192
  ds_read_b128 v[184:187], v113 offset:64
  ds_read_b128 v[188:191], v113 offset:96
  s_waitcnt lgkmcnt(8)
  v_mfma_f32_32x32x16_bf16 v[80:95], v[120:123], v[160:163], 0
  v_mfma_f32_32x32x16_bf16 v[64:79], v[144:147], v[160:163], 0
  v_mfma_f32_32x32x16_bf16 v[80:95], v[124:127], v[164:167], v[80:95]
  v_mfma_f32_32x32x16_bf16 v[64:79], v[148:151], v[164:167], v[64:79]
  v_mfma_f32_32x32x16_bf16 v[80:95], v[144:147], v[168:171], v[80:95]
  v_mfma_f32_32x32x16_bf16 v[64:79], v[136:139], v[168:171], v[64:79]
  v_mfma_f32_32x32x16_bf16 v[80:95], v[148:151], v[172:175], v[80:95]
  v_mfma_f32_32x32x16_bf16 v[64:79], v[140:143], v[172:175], v[64:79]
  v_max_i32 v113, v112, v111
  v_subrev_u32 v112, 144, v112
  ds_read_b128 v[160:163], v113
  ds_read_b128 v[136:139], v110 offset:416
  ds_read_b128 v[144:147], v110 offset:352
  ds_read_b128 v[164:167], v113 offset:32
  ds_read_b128 v[140:143], v110 offset:384
  ds_read_b128 v[148:151], v110 offset:320
  ds_read_b128 v[168:171], v113 offset:64
  ds_read_b128 v[172:175], v113 offset:96
  s_waitcnt lgkmcnt(8)
  v_mfma_f32_32x32x16_bf16 v[80:95], v[128:131], v[176:179], v[80:95]
  v_mfma_f32_32x32x16_bf16 v[64:79], v[152:155], v[176:179], v[64:79]
  v_mfma_f32_32x32x16_bf16 v[80:95], v[132:135], v[180:183], v[80:95]
  v_mfma_f32_32x32x16_bf16 v[64:79], v[156:159], v[180:183], v[64:79]
  v_mfma_f32_32x32x16_bf16 v[80:95], v[152:155], v[184:187], v[80:95]
  v_mfma_f32_32x32x16_bf16 v[64:79], v[120:123], v[184:187], v[64:79]
  v_mfma_f32_32x32x16_bf16 v[80:95], v[156:159], v[188:191], v[80:95]
  v_mfma_f32_32x32x16_bf16 v[64:79], v[124:127], v[188:191], v[64:79]
  v_max_i32 v113, v112, v111
  v_subrev_u32 v112, 144, v112
  ds_read_b128 v[176:179], v113
  ds_read_b128 v[120:123], v110 offset:544
  ds_read_b128 v[152:155], v110 offset:480
  ds_read_b128 v[180:183], v113 offset:32
  ds_read_b128 v[124:127], v110 offset:512
  ds_read_b128 v[156:159], v110 offset:448
  ds_read_b128 v[184:187], v113 offset:64
  ds_read_b128 v[188:191], v113 offset:96
  s_waitcnt lgkmcnt(8)
  v_mfma_f32_32x32x16_bf16 v[80:95], v[136:139], v[160:163], v[80:95]
  v_mfma_f32_32x32x16_bf16 v[64:79], v[144:147], v[160:163], v[64:79]
  s_cmp_eq_u32 s3, 0
  s_cbranch_scc1 L_nw0_20
  s_mov_b32 s76, 37810304
  v_mov_b32 v242, 0
  buffer_load_dword v243, v242, s[40:43], s76 offen sc1
L_nw0_20:
  v_mfma_f32_32x32x16_bf16 v[80:95], v[140:143], v[164:167], v[80:95]
  v_mfma_f32_32x32x16_bf16 v[64:79], v[148:151], v[164:167], v[64:79]
  v_mfma_f32_32x32x16_bf16 v[80:95], v[144:147], v[168:171], v[80:95]
  v_mfma_f32_32x32x16_bf16 v[64:79], v[128:131], v[168:171], v[64:79]
  v_mfma_f32_32x32x16_bf16 v[80:95], v[148:151], v[172:175], v[80:95]
  v_mfma_f32_32x32x16_bf16 v[64:79], v[132:135], v[172:175], v[64:79]
  v_max_i32 v113, v112, v111
  v_subrev_u32 v112, 144, v112
  ds_read_b128 v[160:163], v113
  ds_read_b128 v[128:131], v110 offset:672
  ds_read_b128 v[144:147], v110 offset:608
  ds_read_b128 v[164:167], v113 offset:32
  ds_read_b128 v[132:135], v110 offset:640
  ds_read_b128 v[148:151], v110 offset:576
  ds_read_b128 v[168:171], v113 offset:64
  ds_read_b128 v[172:175], v113 offset:96
  s_waitcnt lgkmcnt(8)
  v_mfma_f32_32x32x16_bf16 v[80:95], v[120:123], v[176:179], v[80:95]
  v_mfma_f32_32x32x16_bf16 v[64:79], v[152:155], v[176:179], v[64:79]
  s_mov_b32 s64, 0
  s_cmp_eq_u32 s3, 0
  s_cbranch_scc1 L_nw0_21
  s_waitcnt vmcnt(0)
  v_cmp_ne_u32 vcc, s70, v243
  s_nop 1
  s_cmp_eq_u64 vcc, 0
  s_cselect_b32 s64, 1, 0
L_nw0_21:
  s_cmp_eq_u32 s64, 0
  s_cbranch_scc1 L_w1c_22
  s_add_u32 m0, s92, 0
  s_add_u32 s93, s94, 0
  buffer_load_dwordx4 v119, s[40:43], s93 offen lds
  s_add_u32 m0, s92, 3072
  s_add_u32 s93, s94, 3072
  buffer_load_dwordx4 v119, s[40:43], s93 offen lds
L_w1c_22:
  v_mfma_f32_32x32x16_bf16 v[80:95], v[124:127], v[180:183], v[80:95]
  v_mfma_f32_32x32x16_bf16 v[64:79], v[156:159], v[180:183], v[64:79]
  v_mfma_f32_32x32x16_bf16 v[80:95], v[152:155], v[184:187], v[80:95]
  v_mfma_f32_32x32x16_bf16 v[64:79], v[136:139], v[184:187], v[64:79]
  v_mfma_f32_32x32x16_bf16 v[80:95], v[156:159], v[188:191], v[80:95]
  v_mfma_f32_32x32x16_bf16 v[64:79], v[140:143], v[188:191], v[64:79]
  v_max_i32 v113, v112, v111
  v_subrev_u32 v112, 144, v112
  ds_read_b128 v[176:179], v113
  ds_read_b128 v[136:139], v110 offset:800
  ds_read_b128 v[152:155], v110 offset:736
  ds_read_b128 v[180:183], v113 offset:32
  ds_read_b128 v[140:143], v110 offset:768
  ds_read_b128 v[156:159], v110 offset:704
  ds_read_b128 v[184:187], v113 offset:64
  ds_read_b128 v[188:191], v113 offset:96
  s_waitcnt lgkmcnt(8)
  v_mfma_f32_32x32x16_bf16 v[80:95], v[128:131], v[160:163], v[80:95]
  v_mfma_f32_32x32x16_bf16 v[64:79], v[144:147], v[160:163], v[64:79]
  s_cmp_eq_u32 s64, 0
  s_cbranch_scc1 L_w1c_23
  s_add_u32 m0, s92, 6144
  s_add_u32 s93, s94, 6144
  buffer_load_dwordx4 v119, s[40:43], s93 offen lds
  s_add_u32 m0, s92, 9216
  s_add_u32 s93, s94, 9216
  buffer_load_dwordx4 v119, s[40:43], s93 offen lds
L_w1c_23:
  v_mfma_f32_32x32x16_bf16 v[80:95], v[132:135], v[164:167], v[80:95]
  v_mfma_f32_32x32x16_bf16 v[64:79], v[148:151], v[164:167], v[64:79]
  v_mfma_f32_32x32x16_bf16 v[80:95], v[144:147], v[168:171], v[80:95]
  v_mfma_f32_32x32x16_bf16 v[64:79], v[120:123], v[168:171], v[64:79]
  v_mfma_f32_32x32x16_bf16 v[80:95], v[148:151], v[172:175], v[80:95]
  v_mfma_f32_32x32x16_bf16 v[64:79], v[124:127], v[172:175], v[64:79]
  v_max_i32 v113, v112, v111
  v_subrev_u32 v112, 144, v112
  ds_read_b128 v[160:163], v113
  ds_read_b128 v[120:123], v110 offset:928
  ds_read_b128 v[144:147], v110 offset:864
  ds_read_b128 v[164:167], v113 offset:32
  ds_read_b128 v[124:127], v110 offset:896
  ds_read_b128 v[148:151], v110 offset:832
  ds_read_b128 v[168:171], v113 offset:64
  ds_read_b128 v[172:175], v113 offset:96
  s_waitcnt lgkmcnt(8)
  v_mfma_f32_32x32x16_bf16 v[80:95], v[136:139], v[176:179], v[80:95]
  v_mfma_f32_32x32x16_bf16 v[64:79], v[152:155], v[176:179], v[64:79]
  s_cmp_eq_u32 s64, 0
  s_cbranch_scc1 L_w1c_24
  s_add_u32 m0, s92, 12288
  s_add_u32 s93, s94, 12288
  buffer_load_dwordx4 v119, s[40:43], s93 offen lds
  s_add_u32 m0, s92, 15360
  s_add_u32 s93, s94, 15360
  buffer_load_dwordx4 v119, s[40:43], s93 offen lds
L_w1c_24:
  v_mfma_f32_32x32x16_bf16 v[80:95], v[140:143], v[180:183], v[80:95]
  v_mfma_f32_32x32x16_bf16 v[64:79], v[156:159], v[180:183], v[64:79]
  v_mfma_f32_32x32x16_bf16 v[80:95], v[152:155], v[184:187], v[80:95]
  v_mfma_f32_32x32x16_bf16 v[64:79], v[128:131], v[184:187], v[64:79]
  v_mfma_f32_32x32x16_bf16 v[80:95], v[156:159], v[188:191], v[80:95]
  v_mfma_f32_32x32x16_bf16 v[64:79], v[132:135], v[188:191], v[64:79]
  v_max_i32 v113, v112, v111
  v_subrev_u32 v112, 144, v112
  ds_read_b128 v[176:179], v113
  ds_read_b128 v[128:131], v110 offset:1056
  ds_read_b128 v[152:155], v110 offset:992
  ds_read_b128 v[180:183], v113 offset:32
  ds_read_b128 v[132:135], v110 offset:1024
  ds_read_b128 v[156:159], v110 offset:960
  ds_read_b128 v[184:187], v113 offset:64
  ds_read_b128 v[188:191], v113 offset:96
  s_waitcnt lgkmcnt(8)
  v_mfma_f32_32x32x16_bf16 v[80:95], v[120:123], v[160:163], v[80:95]
  v_mfma_f32_32x32x16_bf16 v[64:79], v[144:147], v[160:163], v[64:79]
  s_cmp_eq_u32 s64, 0
  s_cbranch_scc1 L_w1c_25
  s_add_u32 m0, s92, 18432
  s_add_u32 s93, s94, 18432
  buffer_load_dwordx4 v119, s[40:43], s93 offen lds
  s_add_u32 m0, s92, 21504
  s_add_u32 s93, s94, 21504
  buffer_load_dwordx4 v119, s[40:43], s93 offen lds
L_w1c_25:
  s_cmp_eq_u32 s64, 0
  s_cbranch_scc1 L_w1c_26
  s_add_u32 m0, s92, 24576
  s_add_u32 s93, s94, 24576
  buffer_load_dwordx4 v119, s[40:43], s93 offen lds
  s_add_u32 m0, s92, 27648
  s_add_u32 s93, s94, 27648
  buffer_load_dwordx4 v119, s[40:43], s93 offen lds
L_w1c_26:
  v_mfma_f32_32x32x16_bf16 v[80:95], v[124:127], v[164:167], v[80:95]
  v_mfma_f32_32x32x16_bf16 v[64:79], v[148:151], v[164:167], v[64:79]
  v_mfma_f32_32x32x16_bf16 v[80:95], v[144:147], v[168:171], v[80:95]
  v_mfma_f32_32x32x16_bf16 v[64:79], v[136:139], v[168:171], v[64:79]
  v_mfma_f32_32x32x16_bf16 v[80:95], v[148:151], v[172:175], v[80:95]
  v_mfma_f32_32x32x16_bf16 v[64:79], v[140:143], v[172:175], v[64:79]
  v_max_i32 v113, v112, v111
  v_subrev_u32 v112, 144, v112
  ds_read_b128 v[160:163], v113
  ds_read_b128 v[136:139], v110 offset:1184
  ds_read_b128 v[144:147], v110 offset:1120
  ds_read_b128 v[164:167], v113 offset:32
  ds_read_b128 v[140:143], v110 offset:1152
  ds_read_b128 v[148:151], v110 offset:1088
  ds_read_b128 v[168:171], v113 offset:64
  ds_read_b128 v[172:175], v113 offset:96
  s_waitcnt lgkmcnt(8)
  v_mfma_f32_32x32x16_bf16 v[80:95], v[128:131], v[176:179], v[80:95]
  v_mfma_f32_32x32x16_bf16 v[64:79], v[152:155], v[176:179], v[64:79]
  s_cmp_eq_u32 s64, 0
  s_cbranch_scc1 L_w1c_27
  s_add_u32 m0, s92, 30720
  s_add_u32 s93, s94, 30720
  buffer_load_dwordx4 v119, s[40:43], s93 offen lds
  s_add_u32 m0, s92, 33792
  s_add_u32 s93, s94, 33792
  buffer_load_dwordx4 v119, s[40:43], s93 offen lds
L_w1c_27:
  v_mfma_f32_32x32x16_bf16 v[80:95], v[132:135], v[180:183], v[80:95]
  v_mfma_f32_32x32x16_bf16 v[64:79], v[156:159], v[180:183], v[64:79]
  v_mfma_f32_32x32x16_bf16 v[80:95], v[152:155], v[184:187], v[80:95]
  v_mfma_f32_32x32x16_bf16 v[64:79], v[120:123], v[184:187], v[64:79]
  v_mfma_f32_32x32x16_bf16 v[80:95], v[156:159], v[188:191], v[80:95]
  v_mfma_f32_32x32x16_bf16 v[64:79], v[124:127], v[188:191], v[64:79]
  v_max_i32 v113, v112, v111
  v_subrev_u32 v112, 144, v112
  ds_read_b128 v[176:179], v113
  ds_read_b128 v[120:123], v110 offset:1312
  ds_read_b128 v[152:155], v110 offset:1248
  ds_read_b128 v[180:183], v113 offset:32
  ds_read_b128 v[124:127], v110 offset:1280
  ds_read_b128 v[156:159], v110 offset:1216
  ds_read_b128 v[184:187], v113 offset:64
  ds_read_b128 v[188:191], v113 offset:96
  s_waitcnt lgkmcnt(8)
  v_mfma_f32_32x32x16_bf16 v[80:95], v[136:139], v[160:163], v[80:95]
  v_mfma_f32_32x32x16_bf16 v[64:79], v[144:147], v[160:163], v[64:79]
  s_cmp_eq_u32 s64, 0
  s_cbranch_scc1 L_w1c_28
  s_add_u32 m0, s92, 36864
  s_add_u32 s93, s94, 36864
  buffer_load_dwordx4 v119, s[40:43], s93 offen lds
  s_add_u32 m0, s92, 39936
  s_add_u32 s93, s94, 39936
  buffer_load_dwordx4 v119, s[40:43], s93 offen lds
L_w1c_28:
  v_mfma_f32_32x32x16_bf16 v[80:95], v[140:143], v[164:167], v[80:95]
  v_mfma_f32_32x32x16_bf16 v[64:79], v[148:151], v[164:167], v[64:79]
  v_mfma_f32_32x32x16_bf16 v[80:95], v[144:147], v[168:171], v[80:95]
  v_mfma_f32_32x32x16_bf16 v[64:79], v[128:131], v[168:171], v[64:79]
  v_mfma_f32_32x32x16_bf16 v[80:95], v[148:151], v[172:175], v[80:95]
  v_mfma_f32_32x32x16_bf16 v[64:79], v[132:135], v[172:175], v[64:79]
  v_max_i32 v113, v112, v111
  v_subrev_u32 v112, 144, v112
  ds_read_b128 v[160:163], v113
  ds_read_b128 v[128:131], v110 offset:1440
  ds_read_b128 v[144:147], v110 offset:1376
  ds_read_b128 v[164:167], v113 offset:32
  ds_read_b128 v[132:135], v110 offset:1408
  ds_read_b128 v[148:151], v110 offset:1344
  ds_read_b128 v[168:171], v113 offset:64
  ds_read_b128 v[172:175], v113 offset:96
  s_waitcnt lgkmcnt(8)
  v_mfma_f32_32x32x16_bf16 v[80:95], v[120:123], v[176:179], v[80:95]
  v_mfma_f32_32x32x16_bf16 v[64:79], v[152:155], v[176:179], v[64:79]
  s_cmp_eq_u32 s64, 0
  s_cbranch_scc1 L_w1c_29
  s_add_u32 m0, s92, 43008
  s_add_u32 s93, s94, 43008
  buffer_load_dwordx4 v119, s[40:43], s93 offen lds
  s_add_u32 m0, s92, 46080
  s_add_u32 s93, s94, 46080
  buffer_load_dwordx4 v119, s[40:43], s93 offen lds
L_w1c_29:
  s_cmp_eq_u32 s64, 0
  s_cbranch_scc1 L_w1c_30
  s_add_u32 m0, s92, 49152
  s_add_u32 s93, s94, 49152
  buffer_load_dwordx4 v119, s[40:43], s93 offen lds
  s_add_u32 m0, s92, 52224
  s_add_u32 s93, s94, 52224
  buffer_load_dwordx4 v119, s[40:43], s93 offen lds
L_w1c_30:
  v_mfma_f32_32x32x16_bf16 v[80:95], v[124:127], v[180:183], v[80:95]
  v_mfma_f32_32x32x16_bf16 v[64:79], v[156:159], v[180:183], v[64:79]
  v_mfma_f32_32x32x16_bf16 v[80:95], v[152:155], v[184:187], v[80:95]
  v_mfma_f32_32x32x16_bf16 v[64:79], v[136:139], v[184:187], v[64:79]
  v_mfma_f32_32x32x16_bf16 v[80:95], v[156:159], v[188:191], v[80:95]
  v_mfma_f32_32x32x16_bf16 v[64:79], v[140:143], v[188:191], v[64:79]
  v_max_i32 v113, v112, v111
  v_subrev_u32 v112, 144, v112
  ds_read_b128 v[176:179], v113
  ds_read_b128 v[136:139], v110 offset:1568
  ds_read_b128 v[152:155], v110 offset:1504
  ds_read_b128 v[180:183], v113 offset:32
  ds_read_b128 v[140:143], v110 offset:1536
  ds_read_b128 v[156:159], v110 offset:1472
  ds_read_b128 v[184:187], v113 offset:64
  ds_read_b128 v[188:191], v113 offset:96
  s_waitcnt lgkmcnt(8)
  v_mfma_f32_32x32x16_bf16 v[80:95], v[128:131], v[160:163], v[80:95]
  v_mfma_f32_32x32x16_bf16 v[64:79], v[144:147], v[160:163], v[64:79]
  s_cmp_eq_u32 s64, 0
  s_cbranch_scc1 L_w1c_31
  s_add_u32 m0, s92, 55296
  s_add_u32 s93, s94, 55296
  buffer_load_dwordx4 v119, s[40:43], s93 offen lds
  s_add_u32 m0, s92, 58368
  s_add_u32 s93, s94, 58368
  buffer_load_dwordx4 v119, s[40:43], s93 offen lds
L_w1c_31:
  v_mfma_f32_32x32x16_bf16 v[80:95], v[132:135], v[164:167], v[80:95]
  v_mfma_f32_32x32x16_bf16 v[64:79], v[148:151], v[164:167], v[64:79]
  v_mfma_f32_32x32x16_bf16 v[80:95], v[144:147], v[168:171], v[80:95]
  v_mfma_f32_32x32x16_bf16 v[64:79], v[120:123], v[168:171], v[64:79]
  v_mfma_f32_32x32x16_bf16 v[80:95], v[148:151], v[172:175], v[80:95]
  v_mfma_f32_32x32x16_bf16 v[64:79], v[124:127], v[172:175], v[64:79]
  s_waitcnt lgkmcnt(0)
  v_mfma_f32_32x32x16_bf16 v[80:95], v[136:139], v[176:179], v[80:95]
  v_mfma_f32_32x32x16_bf16 v[64:79], v[152:155], v[176:179], v[64:79]
  s_cmp_eq_u32 s64, 0
  s_cbranch_scc1 L_w1c_32
  s_add_u32 m0, s92, 61440
  s_add_u32 s93, s94, 61440
  buffer_load_dwordx4 v119, s[40:43], s93 offen lds
  s_add_u32 m0, s92, 64512
  s_add_u32 s93, s94, 64512
  buffer_load_dwordx4 v119, s[40:43], s93 offen lds
L_w1c_32:
  v_mfma_f32_32x32x16_bf16 v[80:95], v[140:143], v[180:183], v[80:95]
  v_mfma_f32_32x32x16_bf16 v[64:79], v[156:159], v[180:183], v[64:79]
  v_mfma_f32_32x32x16_bf16 v[80:95], v[152:155], v[184:187], v[80:95]
  v_mfma_f32_32x32x16_bf16 v[64:79], v[128:131], v[184:187], v[64:79]
  v_mfma_f32_32x32x16_bf16 v[80:95], v[156:159], v[188:191], v[80:95]
  v_mfma_f32_32x32x16_bf16 v[64:79], v[132:135], v[188:191], v[64:79]
  s_branch L_cend_19
L_chi_18:
  ds_read_b128 v[136:139], v110 offset:32
  ds_read_b128 v[140:143], v110 offset:0
  v_max_i32 v113, v112, v111
  v_subrev_u32 v112, 144, v112
  ds_read_b128 v[160:163], v113
  ds_read_b128 v[120:123], v110 offset:160
  ds_read_b128 v[144:147], v110 offset:96
  ds_read_b128 v[164:167], v113 offset:32
  ds_read_b128 v[124:127], v110 offset:128
  ds_read_b128 v[148:151], v110 offset:64
  ds_read_b128 v[168:171], v113 offset:64
  ds_read_b128 v[172:175], v113 offset:96
  v_max_i32 v113, v112, v111
  v_subrev_u32 v112, 144, v112
  ds_read_b128 v[176:179], v113
  ds_read_b128 v[128:131], v110 offset:288
  ds_read_b128 v[152:155], v110 offset:224
  ds_read_b128 v[180:183], v113 offset:32
  ds_read_b128 v[132:135], v110 offset:256
  ds_read_b128 v[156:159], v110 offset:192
  ds_read_b128 v[184:187], v113 offset:64
  ds_read_b128 v[188:191], v113 offset:96
  s_waitcnt lgkmcnt(8)
  v_mfma_f32_32x32x16_bf16 v[80:95], v[120:123], v[160:163], 0
  v_mfma_f32_32x32x16_bf16 v[64:79], v[144:147], v[160:163], 0
  v_mfma_f32_32x32x16_bf16 v[80:95], v[124:127], v[164:167], v[80:95]
  v_mfma_f32_32x32x16_bf16 v[64:79], v[148:151], v[164:167], v[64:79]
  v_mfma_f32_32x32x16_bf16 v[80:95], v[144:147], v[168:171], v[80:95]
  v_mfma_f32_32x32x16_bf16 v[64:79], v[136:139], v[168:171], v[64:79]
  v_mfma_f32_32x32x16_bf16 v[80:95], v[148:151], v[172:175], v[80:95]
  v_mfma_f32_32x32x16_bf16 v[64:79], v[140:143], v[172:175], v[64:79]
  v_max_i32 v113, v112, v111
  v_subrev_u32 v112, 144, v112
  ds_read_b128 v[160:163], v113
  ds_read_b128 v[136:139], v110 offset:416
  ds_read_b128 v[144:147], v110 offset:352
  ds_read_b128 v[164:167], v113 offset:32
  ds_read_b128 v[140:143], v110 offset:384
  ds_read_b128 v[148:151], v110 offset:320
  ds_read_b128 v[168:171], v113 offset:64
  ds_read_b128 v[172:175], v113 offset:96
  s_waitcnt lgkmcnt(8)
  v_mfma_f32_32x32x16_bf16 v[80:95], v[128:131], v[176:179], v[80:95]
  v_mfma_f32_32x32x16_bf16 v[64:79], v[152:155], v[176:179], v[64:79]
  v_mfma_f32_32x32x16_bf16 v[80:95], v[132:135], v[180:183], v[80:95]
  v_mfma_f32_32x32x16_bf16 v[64:79], v[156:159], v[180:183], v[64:79]
  v_mfma_f32_32x32x16_bf16 v[80:95], v[152:155], v[184:187], v[80:95]
  v_mfma_f32_32x32x16_bf16 v[64:79], v[120:123], v[184:187], v[64:79]
  v_mfma_f32_32x32x16_bf16 v[80:95], v[156:159], v[188:191], v[80:95]
  v_mfma_f32_32x32x16_bf16 v[64:79], v[124:127], v[188:191], v[64:79]
  v_max_i32 v113, v112, v111
  v_subrev_u32 v112, 144, v112
  ds_read_b128 v[176:179], v113
  ds_read_b128 v[120:123], v110 offset:544
  ds_read_b128 v[152:155], v110 offset:480
  ds_read_b128 v[180:183], v113 offset:32
  ds_read_b128 v[124:127], v110 offset:512
  ds_read_b128 v[156:159], v110 offset:448
  ds_read_b128 v[184:187], v113 offset:64
  ds_read_b128 v[188:191], v113 offset:96
  s_waitcnt lgkmcnt(8)
  v_mfma_f32_32x32x16_bf16 v[80:95], v[136:139], v[160:163], v[80:95]
  v_mfma_f32_32x32x16_bf16 v[64:79], v[144:147], v[160:163], v[64:79]
  v_mfma_f32_32x32x16_bf16 v[80:95], v[140:143], v[164:167], v[80:95]
  v_mfma_f32_32x32x16_bf16 v[64:79], v[148:151], v[164:167], v[64:79]
  v_mfma_f32_32x32x16_bf16 v[80:95], v[144:147], v[168:171], v[80:95]
  v_mfma_f32_32x32x16_bf16 v[64:79], v[128:131], v[168:171], v[64:79]
  v_mfma_f32_32x32x16_bf16 v[80:95], v[148:151], v[172:175], v[80:95]
  v_mfma_f32_32x32x16_bf16 v[64:79], v[132:135], v[172:175], v[64:79]
  s_waitcnt lgkmcnt(0)
  v_mfma_f32_32x32x16_bf16 v[80:95], v[120:123], v[176:179], v[80:95]
  v_mfma_f32_32x32x16_bf16 v[64:79], v[152:155], v[176:179], v[64:79]
  s_cmp_eq_u32 s3, 0
  s_cbranch_scc1 L_nw0_33
  s_mov_b32 s76, 37810304
  v_mov_b32 v242, 0
  buffer_load_dword v243, v242, s[40:43], s76 offen sc1
L_nw0_33:
  v_mfma_f32_32x32x16_bf16 v[80:95], v[124:127], v[180:183], v[80:95]
  v_mfma_f32_32x32x16_bf16 v[64:79], v[156:159], v[180:183], v[64:79]
  v_mfma_f32_32x32x16_bf16 v[80:95], v[152:155], v[184:187], v[80:95]
  v_mfma_f32_32x32x16_bf16 v[64:79], v[136:139], v[184:187], v[64:79]
  v_mfma_f32_32x32x16_bf16 v[80:95], v[156:159], v[188:191], v[80:95]
  v_mfma_f32_32x32x16_bf16 v[64:79], v[140:143], v[188:191], v[64:79]
  v_and_b32 v46, 1, v114
  v_cmp_eq_u32 vcc, 0, v46
  v_add_u32 v46, 1, v114
  v_lshrrev_b32 v47, 1, v46
  v_mul_u32_u24 v47, 144, v47
  v_and_b32 v46, 1, v46
  v_lshl_add_u32 v47, v46, 6, v47
  v_add3_u32 v44, v47, v111, 64
  v_add_u32 v44, 80, v44
  v_add_u32 v46, 0, v114
  v_lshrrev_b32 v47, 1, v46
  v_mul_u32_u24 v47, 144, v47
  v_and_b32 v46, 1, v46
  v_lshl_add_u32 v47, v46, 6, v47
  v_add3_u32 v45, v47, v111, 64
  v_add_u32 v45, 80, v45
  v_cndmask_b32 v47, v111, v44, vcc
  v_subrev_u32 v44, 144, v44
  ds_read_b128 v[144:147], v47
  ds_read_b128 v[120:123], v110 offset:544
  ds_read_b128 v[148:151], v47 offset:32
  ds_read_b128 v[124:127], v110 offset:512
  v_max_i32 v47, v45, v111
  v_subrev_u32 v45, 144, v45
  ds_read_b128 v[152:155], v47
  ds_read_b128 v[128:131], v110 offset:608
  ds_read_b128 v[156:159], v47 offset:32
  ds_read_b128 v[132:135], v110 offset:576
  v_max_i32 v47, v44, v111
  v_subrev_u32 v44, 144, v44
  ds_read_b128 v[160:163], v47
  ds_read_b128 v[136:139], v110 offset:672
  ds_read_b128 v[164:167], v47 offset:32
  ds_read_b128 v[140:143], v110 offset:640
  s_waitcnt lgkmcnt(8)
  v_mfma_f32_32x32x16_bf16 v[168:183], v[120:123], v[144:147], 0
  v_mfma_f32_32x32x16_bf16 v[168:183], v[124:127], v[148:151], v[168:183]
  v_max_i32 v47, v45, v111
  v_subrev_u32 v45, 144, v45
  ds_read_b128 v[144:147], v47
  ds_read_b128 v[120:123], v110 offset:736
  ds_read_b128 v[148:151], v47 offset:32
  ds_read_b128 v[124:127], v110 offset:704
  s_waitcnt lgkmcnt(8)
  v_mfma_f32_32x32x16_bf16 v[168:183], v[128:131], v[152:155], v[168:183]
  v_mfma_f32_32x32x16_bf16 v[168:183], v[132:135], v[156:159], v[168:183]
  v_max_i32 v47, v44, v111
  v_subrev_u32 v44, 144, v44
  ds_read_b128 v[152:155], v47
  ds_read_b128 v[128:131], v110 offset:800
  ds_read_b128 v[156:159], v47 offset:32
  ds_read_b128 v[132:135], v110 offset:768
  s_waitcnt lgkmcnt(8)
  v_mfma_f32_32x32x16_bf16 v[168:183], v[136:139], v[160:163], v[168:183]
  v_mfma_f32_32x32x16_bf16 v[168:183], v[140:143], v[164:167], v[168:183]
  v_max_i32 v47, v45, v111
  v_subrev_u32 v45, 144, v45
  ds_read_b128 v[160:163], v47
  ds_read_b128 v[136:139], v110 offset:864
  ds_read_b128 v[164:167], v47 offset:32
  ds_read_b128 v[140:143], v110 offset:832
  s_waitcnt lgkmcnt(8)
  v_mfma_f32_32x32x16_bf16 v[168:183], v[120:123], v[144:147], v[168:183]
  s_mov_b32 s64, 0
  s_cmp_eq_u32 s3, 0
  s_cbranch_scc1 L_nw0_34
  s_waitcnt vmcnt(0)
  v_cmp_ne_u32 vcc, s70, v243
  s_nop 1
  s_cmp_eq_u64 vcc, 0
  s_cselect_b32 s64, 1, 0
L_nw0_34:
  s_cmp_eq_u32 s64, 0
  s_cbranch_scc1 L_w1c_35
  s_add_u32 m0, s92, 0
  s_add_u32 s93, s94, 0
  buffer_load_dwordx4 v119, s[40:43], s93 offen lds
  s_add_u32 m0, s92, 3072
  s_add_u32 s93, s94, 3072
  buffer_load_dwordx4 v119, s[40:43], s93 offen lds
L_w1c_35:
  v_mfma_f32_32x32x16_bf16 v[168:183], v[124:127], v[148:151], v[168:183]
  v_max_i32 v47, v44, v111
  v_subrev_u32 v44, 144, v44
  ds_read_b128 v[144:147], v47
  ds_read_b128 v[120:123], v110 offset:928
  ds_read_b128 v[148:151], v47 offset:32
  ds_read_b128 v[124:127], v110 offset:896
  s_waitcnt lgkmcnt(8)
  v_mfma_f32_32x32x16_bf16 v[168:183], v[128:131], v[152:155], v[168:183]
  v_mfma_f32_32x32x16_bf16 v[168:183], v[132:135], v[156:159], v[168:183]
  v_max_i32 v47, v45, v111
  v_subrev_u32 v45, 144, v45
  ds_read_b128 v[152:155], v47
  ds_read_b128 v[128:131], v110 offset:992
  ds_read_b128 v[156:159], v47 offset:32
  ds_read_b128 v[132:135], v110 offset:960
  s_waitcnt lgkmcnt(8)
  v_mfma_f32_32x32x16_bf16 v[168:183], v[136:139], v[160:163], v[168:183]
  v_mfma_f32_32x32x16_bf16 v[168:183], v[140:143], v[164:167], v[168:183]
  v_max_i32 v47, v44, v111
  v_subrev_u32 v44, 144, v44
  ds_read_b128 v[160:163], v47
  ds_read_b128 v[136:139], v110 offset:1056
  ds_read_b128 v[164:167], v47 offset:32
  ds_read_b128 v[140:143], v110 offset:1024
  s_waitcnt lgkmcnt(8)
  v_mfma_f32_32x32x16_bf16 v[168:183], v[120:123], v[144:147], v[168:183]
  s_cmp_eq_u32 s64, 0
  s_cbranch_scc1 L_w1c_36
  s_add_u32 m0, s92, 6144
  s_add_u32 s93, s94, 6144
  buffer_load_dwordx4 v119, s[40:43], s93 offen lds
  s_add_u32 m0, s92, 9216
  s_add_u32 s93, s94, 9216
  buffer_load_dwordx4 v119, s[40:43], s93 offen lds
L_w1c_36:
  v_mfma_f32_32x32x16_bf16 v[168:183], v[124:127], v[148:151], v[168:183]
  v_max_i32 v47, v45, v111
  v_subrev_u32 v45, 144, v45
  ds_read_b128 v[144:147], v47
  ds_read_b128 v[120:123], v110 offset:1120
  ds_read_b128 v[148:151], v47 offset:32
  ds_read_b128 v[124:127], v110 offset:1088
  s_waitcnt lgkmcnt(8)
  v_mfma_f32_32x32x16_bf16 v[168:183], v[128:131], v[152:155], v[168:183]
  v_mfma_f32_32x32x16_bf16 v[168:183], v[132:135], v[156:159], v[168:183]
  v_max_i32 v47, v44, v111
  v_subrev_u32 v44, 144, v44
  ds_read_b128 v[152:155], v47
  ds_read_b128 v[128:131], v110 offset:1184
  ds_read_b128 v[156:159], v47 offset:32
  ds_read_b128 v[132:135], v110 offset:1152
  s_waitcnt lgkmcnt(8)
  v_mfma_f32_32x32x16_bf16 v[168:183], v[136:139], v[160:163], v[168:183]
  v_mfma_f32_32x32x16_bf16 v[168:183], v[140:143], v[164:167], v[168:183]
  v_max_i32 v47, v45, v111
  v_subrev_u32 v45, 144, v45
  ds_read_b128 v[160:163], v47
  ds_read_b128 v[136:139], v110 offset:1248
  ds_read_b128 v[164:167], v47 offset:32
  ds_read_b128 v[140:143], v110 offset:1216
  s_waitcnt lgkmcnt(8)
  v_mfma_f32_32x32x16_bf16 v[168:183], v[120:123], v[144:147], v[168:183]
  s_cmp_eq_u32 s64, 0
  s_cbranch_scc1 L_w1c_37
  s_add_u32 m0, s92, 12288
  s_add_u32 s93, s94, 12288
  buffer_load_dwordx4 v119, s[40:43], s93 offen lds
  s_add_u32 m0, s92, 15360
  s_add_u32 s93, s94, 15360
  buffer_load_dwordx4 v119, s[40:43], s93 offen lds
L_w1c_37:
  v_mfma_f32_32x32x16_bf16 v[168:183], v[124:127], v[148:151], v[168:183]
  v_max_i32 v47, v44, v111
  v_subrev_u32 v44, 144, v44
  ds_read_b128 v[144:147], v47
  ds_read_b128 v[120:123], v110 offset:1312
  ds_read_b128 v[148:151], v47 offset:32
  ds_read_b128 v[124:127], v110 offset:1280
  s_waitcnt lgkmcnt(8)
  v_mfma_f32_32x32x16_bf16 v[168:183], v[128:131], v[152:155], v[168:183]
  v_mfma_f32_32x32x16_bf16 v[168:183], v[132:135], v[156:159], v[168:183]
  v_max_i32 v47, v45, v111
  v_subrev_u32 v45, 144, v45
  ds_read_b128 v[152:155], v47
  ds_read_b128 v[128:131], v110 offset:1376
  ds_read_b128 v[156:159], v47 offset:32
  ds_read_b128 v[132:135], v110 offset:1344
  s_waitcnt lgkmcnt(8)
  v_mfma_f32_32x32x16_bf16 v[168:183], v[136:139], v[160:163], v[168:183]
  v_mfma_f32_32x32x16_bf16 v[168:183], v[140:143], v[164:167], v[168:183]
  v_max_i32 v47, v44, v111
  v_subrev_u32 v44, 144, v44
  ds_read_b128 v[160:163], v47
  ds_read_b128 v[136:139], v110 offset:1440
  ds_read_b128 v[164:167], v47 offset:32
  ds_read_b128 v[140:143], v110 offset:1408
  s_waitcnt lgkmcnt(8)
  v_mfma_f32_32x32x16_bf16 v[168:183], v[120:123], v[144:147], v[168:183]
  s_cmp_eq_u32 s64, 0
  s_cbranch_scc1 L_w1c_38
  s_add_u32 m0, s92, 18432
  s_add_u32 s93, s94, 18432
  buffer_load_dwordx4 v119, s[40:43], s93 offen lds
  s_add_u32 m0, s92, 21504
  s_add_u32 s93, s94, 21504
  buffer_load_dwordx4 v119, s[40:43], s93 offen lds
L_w1c_38:
  v_mfma_f32_32x32x16_bf16 v[168:183], v[124:127], v[148:151], v[168:183]
  v_max_i32 v47, v45, v111
  v_subrev_u32 v45, 144, v45
  ds_read_b128 v[144:147], v47
  ds_read_b128 v[120:123], v110 offset:1504
  ds_read_b128 v[148:151], v47 offset:32
  ds_read_b128 v[124:127], v110 offset:1472
  s_waitcnt lgkmcnt(8)
  v_mfma_f32_32x32x16_bf16 v[168:183], v[128:131], v[152:155], v[168:183]
  v_mfma_f32_32x32x16_bf16 v[168:183], v[132:135], v[156:159], v[168:183]
  v_max_i32 v47, v44, v111
  v_subrev_u32 v44, 144, v44
  ds_read_b128 v[152:155], v47
  ds_read_b128 v[128:131], v110 offset:1568
  ds_read_b128 v[156:159], v47 offset:32
  ds_read_b128 v[132:135], v110 offset:1536
  s_waitcnt lgkmcnt(8)
  v_mfma_f32_32x32x16_bf16 v[168:183], v[136:139], v[160:163], v[168:183]
  v_mfma_f32_32x32x16_bf16 v[168:183], v[140:143], v[164:167], v[168:183]
  v_max_i32 v47, v45, v111
  v_subrev_u32 v45, 144, v45
  ds_read_b128 v[160:163], v47
  ds_read_b128 v[136:139], v110 offset:1632
  ds_read_b128 v[164:167], v47 offset:32
  ds_read_b128 v[140:143], v110 offset:1600
  s_waitcnt lgkmcnt(8)
  v_mfma_f32_32x32x16_bf16 v[168:183], v[120:123], v[144:147], v[168:183]
  s_cmp_eq_u32 s64, 0
  s_cbranch_scc1 L_w1c_39
  s_add_u32 m0, s92, 24576
  s_add_u32 s93, s94, 24576
  buffer_load_dwordx4 v119, s[40:43], s93 offen lds
  s_add_u32 m0, s92, 27648
  s_add_u32 s93, s94, 27648
  buffer_load_dwordx4 v119, s[40:43], s93 offen lds
L_w1c_39:
  v_mfma_f32_32x32x16_bf16 v[168:183], v[124:127], v[148:151], v[168:183]
  v_max_i32 v47, v44, v111
  v_subrev_u32 v44, 144, v44
  ds_read_b128 v[144:147], v47
  ds_read_b128 v[120:123], v110 offset:1696
  ds_read_b128 v[148:151], v47 offset:32
  ds_read_b128 v[124:127], v110 offset:1664
  s_waitcnt lgkmcnt(8)
  v_mfma_f32_32x32x16_bf16 v[168:183], v[128:131], v[152:155], v[168:183]
  v_mfma_f32_32x32x16_bf16 v[168:183], v[132:135], v[156:159], v[168:183]
  v_max_i32 v47, v45, v111
  v_subrev_u32 v45, 144, v45
  ds_read_b128 v[152:155], v47
  ds_read_b128 v[128:131], v110 offset:1760
  ds_read_b128 v[156:159], v47 offset:32
  ds_read_b128 v[132:135], v110 offset:1728
  s_waitcnt lgkmcnt(8)
  v_mfma_f32_32x32x16_bf16 v[168:183], v[136:139], v[160:163], v[168:183]
  v_mfma_f32_32x32x16_bf16 v[168:183], v[140:143], v[164:167], v[168:183]
  v_max_i32 v47, v44, v111
  v_subrev_u32 v44, 144, v44
  ds_read_b128 v[160:163], v47
  ds_read_b128 v[136:139], v110 offset:1824
  ds_read_b128 v[164:167], v47 offset:32
  ds_read_b128 v[140:143], v110 offset:1792
  s_waitcnt lgkmcnt(8)
  v_mfma_f32_32x32x16_bf16 v[168:183], v[120:123], v[144:147], v[168:183]
  s_cmp_eq_u32 s64, 0
  s_cbranch_scc1 L_w1c_40
  s_add_u32 m0, s92, 30720
  s_add_u32 s93, s94, 30720
  buffer_load_dwordx4 v119, s[40:43], s93 offen lds
  s_add_u32 m0, s92, 33792
  s_add_u32 s93, s94, 33792
  buffer_load_dwordx4 v119, s[40:43], s93 offen lds
L_w1c_40:
  v_mfma_f32_32x32x16_bf16 v[168:183], v[124:127], v[148:151], v[168:183]
  v_max_i32 v47, v45, v111
  v_subrev_u32 v45, 144, v45
  ds_read_b128 v[144:147], v47
  ds_read_b128 v[120:123], v110 offset:1888
  ds_read_b128 v[148:151], v47 offset:32
  ds_read_b128 v[124:127], v110 offset:1856
  s_waitcnt lgkmcnt(8)
  v_mfma_f32_32x32x16_bf16 v[168:183], v[128:131], v[152:155], v[168:183]
  v_mfma_f32_32x32x16_bf16 v[168:183], v[132:135], v[156:159], v[168:183]
  v_max_i32 v47, v44, v111
  v_subrev_u32 v44, 144, v44
  ds_read_b128 v[152:155], v47
  ds_read_b128 v[128:131], v110 offset:1952
  ds_read_b128 v[156:159], v47 offset:32
  ds_read_b128 v[132:135], v110 offset:1920
  s_waitcnt lgkmcnt(8)
  v_mfma_f32_32x32x16_bf16 v[168:183], v[136:139], v[160:163], v[168:183]
  v_mfma_f32_32x32x16_bf16 v[168:183], v[140:143], v[164:167], v[168:183]
  v_max_i32 v47, v45, v111
  v_subrev_u32 v45, 144, v45
  ds_read_b128 v[160:163], v47
  ds_read_b128 v[136:139], v110 offset:2016
  ds_read_b128 v[164:167], v47 offset:32
  ds_read_b128 v[140:143], v110 offset:1984
  s_waitcnt lgkmcnt(8)
  v_mfma_f32_32x32x16_bf16 v[168:183], v[120:123], v[144:147], v[168:183]
  s_cmp_eq_u32 s64, 0
  s_cbranch_scc1 L_w1c_41
  s_add_u32 m0, s92, 36864
  s_add_u32 s93, s94, 36864
  buffer_load_dwordx4 v119, s[40:43], s93 offen lds
  s_add_u32 m0, s92, 39936
  s_add_u32 s93, s94, 39936
  buffer_load_dwordx4 v119, s[40:43], s93 offen lds
L_w1c_41:
  v_mfma_f32_32x32x16_bf16 v[168:183], v[124:127], v[148:151], v[168:183]
  v_max_i32 v47, v44, v111
  v_subrev_u32 v44, 144, v44
  ds_read_b128 v[144:147], v47
  ds_read_b128 v[120:123], v110 offset:2080
  ds_read_b128 v[148:151], v47 offset:32
  ds_read_b128 v[124:127], v110 offset:2048
  s_waitcnt lgkmcnt(8)
  v_mfma_f32_32x32x16_bf16 v[168:183], v[128:131], v[152:155], v[168:183]
  v_mfma_f32_32x32x16_bf16 v[168:183], v[132:135], v[156:159], v[168:183]
  v_max_i32 v47, v45, v111
  v_subrev_u32 v45, 144, v45
  ds_read_b128 v[152:155], v47
  ds_read_b128 v[128:131], v110 offset:2144
  ds_read_b128 v[156:159], v47 offset:32
  ds_read_b128 v[132:135], v110 offset:2112
  s_waitcnt lgkmcnt(8)
  v_mfma_f32_32x32x16_bf16 v[168:183], v[136:139], v[160:163], v[168:183]
  v_mfma_f32_32x32x16_bf16 v[168:183], v[140:143], v[164:167], v[168:183]
  v_max_i32 v47, v44, v111
  v_subrev_u32 v44, 144, v44
  ds_read_b128 v[160:163], v47
  ds_read_b128 v[136:139], v110 offset:2208
  ds_read_b128 v[164:167], v47 offset:32
  ds_read_b128 v[140:143], v110 offset:2176
  s_waitcnt lgkmcnt(8)
  v_mfma_f32_32x32x16_bf16 v[168:183], v[120:123], v[144:147], v[168:183]
  s_cmp_eq_u32 s64, 0
  s_cbranch_scc1 L_w1c_42
  s_add_u32 m0, s92, 43008
  s_add_u32 s93, s94, 43008
  buffer_load_dwordx4 v119, s[40:43], s93 offen lds
  s_add_u32 m0, s92, 46080
  s_add_u32 s93, s94, 46080
  buffer_load_dwordx4 v119, s[40:43], s93 offen lds
L_w1c_42:
  v_mfma_f32_32x32x16_bf16 v[168:183], v[124:127], v[148:151], v[168:183]
  v_max_i32 v47, v45, v111
  v_subrev_u32 v45, 144, v45
  ds_read_b128 v[144:147], v47
  ds_read_b128 v[120:123], v110 offset:2272
  ds_read_b128 v[148:151], v47 offset:32
  ds_read_b128 v[124:127], v110 offset:2240
  s_waitcnt lgkmcnt(8)
  v_mfma_f32_32x32x16_bf16 v[168:183], v[128:131], v[152:155], v[168:183]
  v_mfma_f32_32x32x16_bf16 v[168:183], v[132:135], v[156:159], v[168:183]
  v_max_i32 v47, v44, v111
  v_subrev_u32 v44, 144, v44
  ds_read_b128 v[152:155], v47
  ds_read_b128 v[128:131], v110 offset:2336
  ds_read_b128 v[156:159], v47 offset:32
  ds_read_b128 v[132:135], v110 offset:2304
  s_waitcnt lgkmcnt(8)
  v_mfma_f32_32x32x16_bf16 v[168:183], v[136:139], v[160:163], v[168:183]
  v_mfma_f32_32x32x16_bf16 v[168:183], v[140:143], v[164:167], v[168:183]
  v_max_i32 v47, v45, v111
  v_subrev_u32 v45, 144, v45
  ds_read_b128 v[160:163], v47
  ds_read_b128 v[136:139], v110 offset:2400
  ds_read_b128 v[164:167], v47 offset:32
  ds_read_b128 v[140:143], v110 offset:2368
  s_waitcnt lgkmcnt(8)
  v_mfma_f32_32x32x16_bf16 v[168:183], v[120:123], v[144:147], v[168:183]
  s_cmp_eq_u32 s64, 0
  s_cbranch_scc1 L_w1c_43
  s_add_u32 m0, s92, 49152
  s_add_u32 s93, s94, 49152
  buffer_load_dwordx4 v119, s[40:43], s93 offen lds
  s_add_u32 m0, s92, 52224
  s_add_u32 s93, s94, 52224
  buffer_load_dwordx4 v119, s[40:43], s93 offen lds
L_w1c_43:
  v_mfma_f32_32x32x16_bf16 v[168:183], v[124:127], v[148:151], v[168:183]
  v_max_i32 v47, v44, v111
  v_subrev_u32 v44, 144, v44
  ds_read_b128 v[144:147], v47
  ds_read_b128 v[120:123], v110 offset:2464
  ds_read_b128 v[148:151], v47 offset:32
  ds_read_b128 v[124:127], v110 offset:2432
  s_waitcnt lgkmcnt(8)
  v_mfma_f32_32x32x16_bf16 v[168:183], v[128:131], v[152:155], v[168:183]
  v_mfma_f32_32x32x16_bf16 v[168:183], v[132:135], v[156:159], v[168:183]
  v_max_i32 v47, v45, v111
  v_subrev_u32 v45, 144, v45
  ds_read_b128 v[152:155], v47
  ds_read_b128 v[128:131], v110 offset:2528
  ds_read_b128 v[156:159], v47 offset:32
  ds_read_b128 v[132:135], v110 offset:2496
  s_waitcnt lgkmcnt(8)
  v_mfma_f32_32x32x16_bf16 v[168:183], v[136:139], v[160:163], v[168:183]
  v_mfma_f32_32x32x16_bf16 v[168:183], v[140:143], v[164:167], v[168:183]
  v_max_i32 v47, v44, v111
  v_subrev_u32 v44, 144, v44
  ds_read_b128 v[160:163], v47
  ds_read_b128 v[136:139], v110 offset:2592
  ds_read_b128 v[164:167], v47 offset:32
  ds_read_b128 v[140:143], v110 offset:2560
  s_waitcnt lgkmcnt(8)
  v_mfma_f32_32x32x16_bf16 v[168:183], v[120:123], v[144:147], v[168:183]
  s_cmp_eq_u32 s64, 0
  s_cbranch_scc1 L_w1c_44
  s_add_u32 m0, s92, 55296
  s_add_u32 s93, s94, 55296
  buffer_load_dwordx4 v119, s[40:43], s93 offen lds
  s_add_u32 m0, s92, 58368
  s_add_u32 s93, s94, 58368
  buffer_load_dwordx4 v119, s[40:43], s93 offen lds
L_w1c_44:
  v_mfma_f32_32x32x16_bf16 v[168:183], v[124:127], v[148:151], v[168:183]
  s_waitcnt lgkmcnt(4)
  v_mfma_f32_32x32x16_bf16 v[168:183], v[128:131], v[152:155], v[168:183]
  v_mfma_f32_32x32x16_bf16 v[168:183], v[132:135], v[156:159], v[168:183]
  s_waitcnt lgkmcnt(0)
  v_mfma_f32_32x32x16_bf16 v[168:183], v[136:139], v[160:163], v[168:183]
  v_mfma_f32_32x32x16_bf16 v[168:183], v[140:143], v[164:167], v[168:183]
  s_cmp_eq_u32 s64, 0
  s_cbranch_scc1 L_w1c_45
  s_add_u32 m0, s92, 61440
  s_add_u32 s93, s94, 61440
  buffer_load_dwordx4 v119, s[40:43], s93 offen lds
  s_add_u32 m0, s92, 64512
  s_add_u32 s93, s94, 64512
  buffer_load_dwordx4 v119, s[40:43], s93 offen lds
L_w1c_45:
L_cend_19:
  v_mul_u32_u24 v18, 144, v114
  v_xor_b32 v19, 1, v115
  v_lshl_add_u32 v19, v19, 3, v18
  s_lshl_b32 s15, s88, 6
  s_add_u32 s15, s15, s90
  v_add_u32 v19, s15, v19
  ds_read_b64 v[96:97], v19 offset:35216
  ds_read_b64 v[98:99], v19 offset:35232
  ds_read_b64 v[100:101], v19 offset:35248
  ds_read_b64 v[102:103], v19 offset:35264
  s_lshl_b32 s13, s88, 12
  s_add_u32 s13, s13, s90
  v_lshl_add_u32 v16, v0, 4, s13
  s_xor_b32 s14, s88, 1
  s_lshl_b32 s14, s14, 12
  s_add_u32 s14, s14, s90
  v_lshl_add_u32 v17, v0, 4, s14
  v_lshl_add_u32 v18, v115, 3, v18
  v_add_u32 v18, s15, v18
  s_barrier
  s_cmp_lg_u32 s88, 0
  s_cbranch_scc1 L_cx_46
  ds_write_b128 v16, v[80:83] offset:0
  ds_write_b128 v16, v[84:87] offset:1024
  ds_write_b128 v16, v[88:91] offset:2048
  ds_write_b128 v16, v[92:95] offset:3072
  s_branch L_cy_47
L_cx_46:
  ds_write_b128 v16, v[64:67] offset:0
  ds_write_b128 v16, v[68:71] offset:1024
  ds_write_b128 v16, v[72:75] offset:2048
  ds_write_b128 v16, v[76:79] offset:3072
  v_mul_u32_u24 v44, 144, v114
  v_lshl_add_u32 v44, v115, 4, v44
  v_add_u32 v44, s90, v44
  ds_write_b128 v44, v[168:171] offset:13312
  ds_write_b128 v44, v[172:175] offset:13344
  ds_write_b128 v44, v[176:179] offset:13376
  ds_write_b128 v44, v[180:183] offset:13408
  v_mov_b32 v48, 0
  v_mov_b32 v49, 0
  v_mov_b32 v50, 0
  v_mov_b32 v51, 0
  v_and_b32 v44, 7, v0
  v_lshl_add_u32 v44, v44, 4, s90
  ds_write_b128 v44, v[48:51] offset:17920
  v_mov_b64 v[64:65], v[80:81]
  v_mov_b64 v[66:67], v[82:83]
  v_mov_b64 v[68:69], v[84:85]
  v_mov_b64 v[70:71], v[86:87]
  v_mov_b64 v[72:73], v[88:89]
  v_mov_b64 v[74:75], v[90:91]
  v_mov_b64 v[76:77], v[92:93]
  v_mov_b64 v[78:79], v[94:95]
L_cy_47:
  s_waitcnt lgkmcnt(0)
  s_barrier
  ds_read_b128 v[80:83], v17 offset:0
  ds_read_b128 v[84:87], v17 offset:1024
  ds_read_b128 v[88:91], v17 offset:2048
  ds_read_b128 v[92:95], v17 offset:3072
  v_subrev_u32 v44, 16, v114
  v_lshl_add_u32 v44, v44, 1, s88
  v_cmp_gt_u32 vcc, 16, v114
  v_mov_b32 v45, 32
  s_nop 0
  v_cndmask_b32 v44, v44, v45, vcc
  v_mul_u32_u24 v44, 144, v44
  v_lshl_add_u32 v44, v115, 4, v44
  v_add_u32 v44, s90, v44
  ds_read_b128 v[144:147], v44 offset:13312
  ds_read_b128 v[148:151], v44 offset:13344
  ds_read_b128 v[152:155], v44 offset:13376
  ds_read_b128 v[156:159], v44 offset:13408
  v_and_b32 v120, s12, v97
  v_lshlrev_b32 v121, 16, v97
  v_and_b32 v122, s12, v96
  v_lshlrev_b32 v123, 16, v96
  v_mul_f32 v120, v109, v120
  v_mul_f32 v121, v109, v121
  v_mul_f32 v122, v109, v122
  v_mul_f32 v123, v109, v123
  v_cvt_pk_bf16_f32 v120, v120, v121
  v_and_b32 v121, s12, v120
  v_lshlrev_b32 v120, 16, v120
  v_cvt_pk_bf16_f32 v122, v122, v123
  v_and_b32 v123, s12, v122
  v_lshlrev_b32 v122, 16, v122
  v_and_b32 v124, s12, v99
  v_lshlrev_b32 v125, 16, v99
  v_and_b32 v126, s12, v98
  v_lshlrev_b32 v127, 16, v98
  v_mul_f32 v124, v109, v124
  v_mul_f32 v125, v109, v125
  v_mul_f32 v126, v109, v126
  v_mul_f32 v127, v109, v127
  v_cvt_pk_bf16_f32 v124, v124, v125
  v_and_b32 v125, s12, v124
  v_lshlrev_b32 v124, 16, v124
  v_cvt_pk_bf16_f32 v126, v126, v127
  v_and_b32 v127, s12, v126
  v_lshlrev_b32 v126, 16, v126
  v_and_b32 v128, s12, v101
  v_lshlrev_b32 v129, 16, v101
  v_and_b32 v130, s12, v100
  v_lshlrev_b32 v131, 16, v100
  v_mul_f32 v128, v109, v128
  v_mul_f32 v129, v109, v129
  v_mul_f32 v130, v109, v130
  v_mul_f32 v131, v109, v131
  v_cvt_pk_bf16_f32 v128, v128, v129
  v_and_b32 v129, s12, v128
  v_lshlrev_b32 v128, 16, v128
  v_cvt_pk_bf16_f32 v130, v130, v131
  v_and_b32 v131, s12, v130
  v_lshlrev_b32 v130, 16, v130
  v_and_b32 v132, s12, v103
  v_lshlrev_b32 v133, 16, v103
  v_and_b32 v134, s12, v102
  v_lshlrev_b32 v135, 16, v102
  v_mul_f32 v132, v109, v132
  v_mul_f32 v133, v109, v133
  v_mul_f32 v134, v109, v134
  v_mul_f32 v135, v109, v135
  v_cvt_pk_bf16_f32 v132, v132, v133
  v_and_b32 v133, s12, v132
  v_lshlrev_b32 v132, 16, v132
  v_cvt_pk_bf16_f32 v134, v134, v135
  v_and_b32 v135, s12, v134
  v_lshlrev_b32 v134, 16, v134
  s_waitcnt lgkmcnt(0)
  v_pk_add_f32 v[64:65], v[64:65], v[80:81]
  v_pk_add_f32 v[64:65], v[64:65], v[144:145]
  v_cvt_pk_bf16_f32 v64, v64, v65
  v_and_b32 v65, s12, v64
  v_lshlrev_b32 v64, 16, v64
  v_pk_add_f32 v[64:65], v[64:65], v[120:121]
  v_cvt_pk_bf16_f32 v80, v64, v65
  v_pk_add_f32 v[66:67], v[66:67], v[82:83]
  v_pk_add_f32 v[66:67], v[66:67], v[146:147]
  v_cvt_pk_bf16_f32 v66, v66, v67
  v_and_b32 v67, s12, v66
  v_lshlrev_b32 v66, 16, v66
  v_pk_add_f32 v[66:67], v[66:67], v[122:123]
  v_cvt_pk_bf16_f32 v81, v66, v67
  v_pk_add_f32 v[68:69], v[68:69], v[84:85]
  v_pk_add_f32 v[68:69], v[68:69], v[148:149]
  v_cvt_pk_bf16_f32 v68, v68, v69
  v_and_b32 v69, s12, v68
  v_lshlrev_b32 v68, 16, v68
  v_pk_add_f32 v[68:69], v[68:69], v[124:125]
  v_cvt_pk_bf16_f32 v82, v68, v69
  v_pk_add_f32 v[70:71], v[70:71], v[86:87]
  v_pk_add_f32 v[70:71], v[70:71], v[150:151]
  v_cvt_pk_bf16_f32 v70, v70, v71
  v_and_b32 v71, s12, v70
  v_lshlrev_b32 v70, 16, v70
  v_pk_add_f32 v[70:71], v[70:71], v[126:127]
  v_cvt_pk_bf16_f32 v83, v70, v71
  v_pk_add_f32 v[72:73], v[72:73], v[88:89]
  v_pk_add_f32 v[72:73], v[72:73], v[152:153]
  v_cvt_pk_bf16_f32 v72, v72, v73
  v_and_b32 v73, s12, v72
  v_lshlrev_b32 v72, 16, v72
  v_pk_add_f32 v[72:73], v[72:73], v[128:129]
  v_cvt_pk_bf16_f32 v84, v72, v73
  v_pk_add_f32 v[74:75], v[74:75], v[90:91]
  v_pk_add_f32 v[74:75], v[74:75], v[154:155]
  v_cvt_pk_bf16_f32 v74, v74, v75
  v_and_b32 v75, s12, v74
  v_lshlrev_b32 v74, 16, v74
  v_pk_add_f32 v[74:75], v[74:75], v[130:131]
  v_cvt_pk_bf16_f32 v85, v74, v75
  v_pk_add_f32 v[76:77], v[76:77], v[92:93]
  v_pk_add_f32 v[76:77], v[76:77], v[156:157]
  v_cvt_pk_bf16_f32 v76, v76, v77
  v_and_b32 v77, s12, v76
  v_lshlrev_b32 v76, 16, v76
  v_pk_add_f32 v[76:77], v[76:77], v[132:133]
  v_cvt_pk_bf16_f32 v86, v76, v77
  v_pk_add_f32 v[78:79], v[78:79], v[94:95]
  v_pk_add_f32 v[78:79], v[78:79], v[158:159]
  v_cvt_pk_bf16_f32 v78, v78, v79
  v_and_b32 v79, s12, v78
  v_lshlrev_b32 v78, 16, v78
  v_pk_add_f32 v[78:79], v[78:79], v[134:135]
  v_cvt_pk_bf16_f32 v87, v78, v79
  ds_write_b64 v18, v[80:81] offset:8192
  ds_write_b64 v18, v[82:83] offset:8208
  ds_write_b64 v18, v[84:85] offset:8224
  ds_write_b64 v18, v[86:87] offset:8240
  s_waitcnt lgkmcnt(0)
  s_barrier
  s_cmp_lg_u32 s3, 0
  s_cbranch_scc1 L_w0_48
  v_lshrrev_b32 v16, 3, v0
  v_mul_u32_u24 v16, 144, v16
  v_and_b32 v17, 7, v0
  v_lshl_add_u32 v16, v17, 4, v16
  v_add_u32 v16, 83968, v16
  ds_read_b128 v[20:23], v16 offset:8192
  ds_read_b128 v[24:27], v16 offset:9344
  ds_read_b128 v[28:31], v16 offset:10496
  ds_read_b128 v[32:35], v16 offset:11648
  ds_read_b128 v[36:39], v16 offset:48128
  ds_read_b128 v[40:43], v16 offset:49280
  ds_read_b128 v[44:47], v16 offset:50432
  ds_read_b128 v[48:51], v16 offset:51584
  s_add_u32 s11, s89, 2097152
  s_add_u32 s13, s11, 4096
  s_waitcnt lgkmcnt(7)
  buffer_store_dwordx4 v[20:23], v119, s[40:43], s11 offen offset:0 sc1
  s_waitcnt lgkmcnt(6)
  buffer_store_dwordx4 v[24:27], v119, s[40:43], s11 offen offset:1024 sc1
  s_waitcnt lgkmcnt(5)
  buffer_store_dwordx4 v[28:31], v119, s[40:43], s11 offen offset:2048 sc1
  s_waitcnt lgkmcnt(4)
  buffer_store_dwordx4 v[32:35], v119, s[40:43], s11 offen offset:3072 sc1
  s_waitcnt lgkmcnt(3)
  buffer_store_dwordx4 v[36:39], v119, s[40:43], s13 offen offset:0 sc1
  s_waitcnt lgkmcnt(2)
  buffer_store_dwordx4 v[40:43], v119, s[40:43], s13 offen offset:1024 sc1
  s_waitcnt lgkmcnt(1)
  buffer_store_dwordx4 v[44:47], v119, s[40:43], s13 offen offset:2048 sc1
  s_waitcnt lgkmcnt(0)
  buffer_store_dwordx4 v[48:51], v119, s[40:43], s13 offen offset:3072 sc1
  s_barrier
  s_waitcnt vmcnt(0)
  s_lshl_b32 s76, s4, 4
  s_add_u32 s76, s76, s5
  s_lshl_b32 s76, s76, 2
  v_cmp_eq_u32 vcc, 0, v0
  v_mov_b32 v244, 0x7ffffff0
  s_nop 0
  v_cndmask_b32 v242, v244, 0, vcc
  s_add_u32 s77, s76, 37793792
  buffer_store_dword v245, v242, s[40:43], s77 offen sc1
  s_branch L_w2_50
L_w0_48:
  s_barrier
  s_mov_b32 s10, 1
  s_cmp_lg_u32 s3, 1
  s_cbranch_scc1 L_xc_51
  s_and_b32 s76, s2, 7
  s_lshl_b32 s76, s76, 9
  s_add_u32 s76, s76, 37801984
  v_and_b32 v242, 31, v0
  v_lshlrev_b32 v242, 4, v242
  s_mov_b32 s77, 0
L_poll_52:
  buffer_load_dword v243, v242, s[40:43], s76 offen sc1
  s_add_u32 s77, s77, 1
  s_waitcnt vmcnt(0)
  v_xor_b32 v244, s70, v243
  v_cmp_lt_u32 vcc, 7, v244
  s_cmp_ge_u32 s77, 400000
  s_cbranch_scc1 L_pdone_53
  s_cbranch_vccnz L_poll_52
L_pdone_53:
  s_or_b32 s10, s70, s68
  v_cmp_ne_u32 vcc, s10, v243
  v_mov_b32 v244, 100352
  v_mov_b32 v249, s70
  s_cmp_eq_u64 vcc, 0
  s_cselect_b32 s10, 1, 0
  v_mov_b32 v248, s10
  ds_write_b64 v244, v[248:249]
L_xc_51:
  s_cmp_lg_u32 s10, 0
  s_cbranch_scc1 L_w2_50
  ds_read_b128 v[16:19], v4 offset:0
  ds_read_b128 v[20:23], v4 offset:1088
  ds_read_b128 v[24:27], v4 offset:2176
  ds_read_b128 v[28:31], v4 offset:3264
  ds_read_b128 v[32:35], v4 offset:4352
  ds_read_b128 v[36:39], v4 offset:5440
  ds_read_b128 v[40:43], v4 offset:6528
  ds_read_b128 v[44:47], v4 offset:7616
  s_mov_b32 s8, 0
  s_waitcnt lgkmcnt(7)
  buffer_store_dwordx4 v[16:19], v10, s[40:43], s8 offen sc1
  s_mov_b32 s8, 32768
  s_waitcnt lgkmcnt(6)
  buffer_store_dwordx4 v[20:23], v10, s[40:43], s8 offen sc1
  s_mov_b32 s8, 65536
  s_waitcnt lgkmcnt(5)
  buffer_store_dwordx4 v[24:27], v10, s[40:43], s8 offen sc1
  s_mov_b32 s8, 98304
  s_waitcnt lgkmcnt(4)
  buffer_store_dwordx4 v[28:31], v10, s[40:43], s8 offen sc1
  s_mov_b32 s8, 131072
  s_waitcnt lgkmcnt(3)
  buffer_store_dwordx4 v[32:35], v10, s[40:43], s8 offen sc1
  s_mov_b32 s8, 163840
  s_waitcnt lgkmcnt(2)
  buffer_store_dwordx4 v[36:39], v10, s[40:43], s8 offen sc1
  s_mov_b32 s8, 196608
  s_waitcnt lgkmcnt(1)
  buffer_store_dwordx4 v[40:43], v10, s[40:43], s8 offen sc1
  s_mov_b32 s8, 229376
  s_waitcnt lgkmcnt(0)
  buffer_store_dwordx4 v[44:47], v10, s[40:43], s8 offen sc1
  s_lshl_b32 s76, s66, 2
  s_add_u32 s76, s76, 37797888
  v_cmp_eq_u32 vcc, 0, v0
  v_mov_b32 v244, 0x7ffffff0
  v_or_b32 v243, s68, v245
  v_cndmask_b32 v244, v244, 0, vcc
  s_waitcnt vmcnt(0)
  buffer_store_dword v245, v244, s[40:43], s76 offen sc1
L_w2_50:
  s_cmp_eq_u32 s3, 0
  s_cbranch_scc1 L_nw0_54
  s_cmp_lg_u32 s64, 0
  s_cbranch_scc1 L_w1go_55
  s_mov_b32 s76, 37810304
  v_mov_b32 v242, 0
  s_mov_b32 s77, 0
L_poll_56:
  s_sleep 8
  buffer_load_dword v243, v242, s[40:43], s76 offen sc1
  s_add_u32 s77, s77, 1
  s_waitcnt vmcnt(0)
  v_cmp_ne_u32 vcc, s70, v243
  s_cmp_ge_u32 s77, 400000
  s_cbranch_scc1 L_pdone_57
  s_cbranch_vccnz L_poll_56
L_pdone_57:
  s_add_u32 m0, s92, 0
  s_add_u32 s93, s94, 0
  buffer_load_dwordx4 v119, s[40:43], s93 offen lds
  s_add_u32 m0, s92, 3072
  s_add_u32 s93, s94, 3072
  buffer_load_dwordx4 v119, s[40:43], s93 offen lds
  s_add_u32 m0, s92, 6144
  s_add_u32 s93, s94, 6144
  buffer_load_dwordx4 v119, s[40:43], s93 offen lds
  s_add_u32 m0, s92, 9216
  s_add_u32 s93, s94, 9216
  buffer_load_dwordx4 v119, s[40:43], s93 offen lds
  s_add_u32 m0, s92, 12288
  s_add_u32 s93, s94, 12288
  buffer_load_dwordx4 v119, s[40:43], s93 offen lds
  s_add_u32 m0, s92, 15360
  s_add_u32 s93, s94, 15360
  buffer_load_dwordx4 v119, s[40:43], s93 offen lds
  s_add_u32 m0, s92, 18432
  s_add_u32 s93, s94, 18432
  buffer_load_dwordx4 v119, s[40:43], s93 offen lds
  s_add_u32 m0, s92, 21504
  s_add_u32 s93, s94, 21504
  buffer_load_dwordx4 v119, s[40:43], s93 offen lds
  s_add_u32 m0, s92, 24576
  s_add_u32 s93, s94, 24576
  buffer_load_dwordx4 v119, s[40:43], s93 offen lds
  s_add_u32 m0, s92, 27648
  s_add_u32 s93, s94, 27648
  buffer_load_dwordx4 v119, s[40:43], s93 offen lds
  s_add_u32 m0, s92, 30720
  s_add_u32 s93, s94, 30720
  buffer_load_dwordx4 v119, s[40:43], s93 offen lds
  s_add_u32 m0, s92, 33792
  s_add_u32 s93, s94, 33792
  buffer_load_dwordx4 v119, s[40:43], s93 offen lds
  s_add_u32 m0, s92, 36864
  s_add_u32 s93, s94, 36864
  buffer_load_dwordx4 v119, s[40:43], s93 offen lds
  s_add_u32 m0, s92, 39936
  s_add_u32 s93, s94, 39936
  buffer_load_dwordx4 v119, s[40:43], s93 offen lds
  s_add_u32 m0, s92, 43008
  s_add_u32 s93, s94, 43008
  buffer_load_dwordx4 v119, s[40:43], s93 offen lds
  s_add_u32 m0, s92, 46080
  s_add_u32 s93, s94, 46080
  buffer_load_dwordx4 v119, s[40:43], s93 offen lds
  s_add_u32 m0, s92, 49152
  s_add_u32 s93, s94, 49152
  buffer_load_dwordx4 v119, s[40:43], s93 offen lds
  s_add_u32 m0, s92, 52224
  s_add_u32 s93, s94, 52224
  buffer_load_dwordx4 v119, s[40:43], s93 offen lds
  s_add_u32 m0, s92, 55296
  s_add_u32 s93, s94, 55296
  buffer_load_dwordx4 v119, s[40:43], s93 offen lds
  s_add_u32 m0, s92, 58368
  s_add_u32 s93, s94, 58368
  buffer_load_dwordx4 v119, s[40:43], s93 offen lds
  s_add_u32 m0, s92, 61440
  s_add_u32 s93, s94, 61440
  buffer_load_dwordx4 v119, s[40:43], s93 offen lds
  s_add_u32 m0, s92, 64512
  s_add_u32 s93, s94, 64512
  buffer_load_dwordx4 v119, s[40:43], s93 offen lds
L_w1go_55:
  s_add_u32 m0, s92, 67584
  s_add_u32 s93, s94, 67584
  buffer_load_dwordx4 v119, s[40:43], s93 offen lds
  s_add_u32 m0, s92, 70656
  s_add_u32 s93, s94, 70656
  buffer_load_dwordx4 v119, s[40:43], s93 offen lds
L_nw0_54:
  s_branch L_join_3
L_pathB_2:
  s_lshr_b32 s88, s2, 3
  s_lshl_b32 s88, s88, 2
  s_add_u32 s88, s88, s3
  s_cmp_ge_u32 s88, 112
  s_cbranch_scc1 L_rl_done_58
  s_lshl_b32 s91, s3, 14
  v_lshrrev_b32 v12, 3, v0
  v_and_b32 v13, 7, v0
  v_lshlrev_b32 v13, 4, v13
  v_lshlrev_b32 v5, 4, v0
  v_bfe_u32 v6, v0, 2, 2
  v_lshlrev_b32 v4, 7, v6
  v_and_b32 v6, 3, v0
  v_lshl_add_u32 v4, v6, 3, v4
  v_add_u32 v4, s91, v4
  s_mov_b32 s80, s30
  s_mov_b32 s81, s31
  s_mov_b32 s82, 0x188000
  s_mov_b32 s83, 0x20000
  s_lshr_b32 s89, s88, 2
  s_and_b32 s6, s88, 3
  s_lshl_b32 s90, s6, 2
  s_cmp_eq_u32 s6, 3
  s_cselect_b32 s90, 11, s90
  s_lshr_b32 s7, s6, 1
  v_lshrrev_b32 v6, 4, v0
  v_lshl_add_u32 v4, v6, 10, v4
  s_mul_i32 s9, s89, 57344
  s_lshl_b32 s11, s90, 10
  s_add_u32 s9, s9, s11
  s_add_u32 s9, s9, 33554432
  s_lshl_b32 s10, s89, 7
  s_mul_i32 s11, s90, 114688
  s_add_u32 s10, s10, s11
  v_mul_u32_u24 v14, 3584, v12
  v_add_u32 v14, v14, v13
  s_add_u32 m0, s91, 0
  s_add_u32 s11, s10, 0
  buffer_load_dwordx4 v14, s[80:83], s11 offen lds
  s_add_u32 m0, s91, 1024
  s_add_u32 s11, s10, 28672
  buffer_load_dwordx4 v14, s[80:83], s11 offen lds
  s_add_u32 m0, s91, 2048
  s_add_u32 s11, s10, 57344
  buffer_load_dwordx4 v14, s[80:83], s11 offen lds
  s_add_u32 m0, s91, 3072
  s_add_u32 s11, s10, 86016
  buffer_load_dwordx4 v14, s[80:83], s11 offen lds
  s_add_u32 m0, s91, 4096
  s_add_u32 s11, s10, 114688
  buffer_load_dwordx4 v14, s[80:83], s11 offen lds
  s_add_u32 m0, s91, 5120
  s_add_u32 s11, s10, 143360
  buffer_load_dwordx4 v14, s[80:83], s11 offen lds
  s_add_u32 m0, s91, 6144
  s_add_u32 s11, s10, 172032
  buffer_load_dwordx4 v14, s[80:83], s11 offen lds
  s_add_u32 m0, s91, 7168
  s_add_u32 s11, s10, 200704
  buffer_load_dwordx4 v14, s[80:83], s11 offen lds
  s_add_u32 m0, s91, 8192
  s_add_u32 s11, s10, 229376
  buffer_load_dwordx4 v14, s[80:83], s11 offen lds
  s_add_u32 m0, s91, 9216
  s_add_u32 s11, s10, 258048
  buffer_load_dwordx4 v14, s[80:83], s11 offen lds
  s_add_u32 m0, s91, 10240
  s_add_u32 s11, s10, 286720
  buffer_load_dwordx4 v14, s[80:83], s11 offen lds
  s_add_u32 m0, s91, 11264
  s_add_u32 s11, s10, 315392
  buffer_load_dwordx4 v14, s[80:83], s11 offen lds
  s_add_u32 m0, s91, 12288
  s_add_u32 s11, s10, 344064
  buffer_load_dwordx4 v14, s[80:83], s11 offen lds
  s_add_u32 m0, s91, 13312
  s_add_u32 s11, s10, 372736
  buffer_load_dwordx4 v14, s[80:83], s11 offen lds
  s_add_u32 m0, s91, 14336
  s_add_u32 s11, s10, 401408
  buffer_load_dwordx4 v14, s[80:83], s11 offen lds
  s_add_u32 m0, s91, 15360
  s_add_u32 s11, s10, 430080
  buffer_load_dwordx4 v14, s[80:83], s11 offen lds
  s_waitcnt vmcnt(12)
  ds_read_b64_tr_b16 v[16:17], v4 offset:0
  ds_read_b64_tr_b16 v[18:19], v4 offset:512
  ds_read_b64_tr_b16 v[20:21], v4 offset:32
  ds_read_b64_tr_b16 v[22:23], v4 offset:544
  ds_read_b64_tr_b16 v[24:25], v4 offset:64
  ds_read_b64_tr_b16 v[26:27], v4 offset:576
  ds_read_b64_tr_b16 v[28:29], v4 offset:96
  ds_read_b64_tr_b16 v[30:31], v4 offset:608
  s_add_u32 s11, s9, 0
  s_waitcnt lgkmcnt(6)
  buffer_store_dwordx4 v[16:19], v5, s[40:43], s11 offen sc1
  s_add_u32 s11, s9, 14336
  s_waitcnt lgkmcnt(4)
  buffer_store_dwordx4 v[20:23], v5, s[40:43], s11 offen sc1
  s_add_u32 s11, s9, 28672
  s_waitcnt lgkmcnt(2)
  buffer_store_dwordx4 v[24:27], v5, s[40:43], s11 offen sc1
  s_add_u32 s11, s9, 43008
  s_waitcnt lgkmcnt(0)
  buffer_store_dwordx4 v[28:31], v5, s[40:43], s11 offen sc1
  s_waitcnt vmcnt(12)
  ds_read_b64_tr_b16 v[32:33], v4 offset:4096
  ds_read_b64_tr_b16 v[34:35], v4 offset:4608
  ds_read_b64_tr_b16 v[36:37], v4 offset:4128
  ds_read_b64_tr_b16 v[38:39], v4 offset:4640
  ds_read_b64_tr_b16 v[40:41], v4 offset:4160
  ds_read_b64_tr_b16 v[42:43], v4 offset:4672
  ds_read_b64_tr_b16 v[44:45], v4 offset:4192
  ds_read_b64_tr_b16 v[46:47], v4 offset:4704
  s_add_u32 s11, s9, 1024
  s_waitcnt lgkmcnt(6)
  buffer_store_dwordx4 v[32:35], v5, s[40:43], s11 offen sc1
  s_add_u32 s11, s9, 15360
  s_waitcnt lgkmcnt(4)
  buffer_store_dwordx4 v[36:39], v5, s[40:43], s11 offen sc1
  s_add_u32 s11, s9, 29696
  s_waitcnt lgkmcnt(2)
  buffer_store_dwordx4 v[40:43], v5, s[40:43], s11 offen sc1
  s_add_u32 s11, s9, 44032
  s_waitcnt lgkmcnt(0)
  buffer_store_dwordx4 v[44:47], v5, s[40:43], s11 offen sc1
  s_waitcnt vmcnt(12)
  ds_read_b64_tr_b16 v[48:49], v4 offset:8192
  ds_read_b64_tr_b16 v[50:51], v4 offset:8704
  ds_read_b64_tr_b16 v[52:53], v4 offset:8224
  ds_read_b64_tr_b16 v[54:55], v4 offset:8736
  ds_read_b64_tr_b16 v[56:57], v4 offset:8256
  ds_read_b64_tr_b16 v[58:59], v4 offset:8768
  ds_read_b64_tr_b16 v[60:61], v4 offset:8288
  ds_read_b64_tr_b16 v[62:63], v4 offset:8800
  s_add_u32 s11, s9, 2048
  s_waitcnt lgkmcnt(6)
  buffer_store_dwordx4 v[48:51], v5, s[40:43], s11 offen sc1
  s_add_u32 s11, s9, 16384
  s_waitcnt lgkmcnt(4)
  buffer_store_dwordx4 v[52:55], v5, s[40:43], s11 offen sc1
  s_add_u32 s11, s9, 30720
  s_waitcnt lgkmcnt(2)
  buffer_store_dwordx4 v[56:59], v5, s[40:43], s11 offen sc1
  s_add_u32 s11, s9, 45056
  s_waitcnt lgkmcnt(0)
  buffer_store_dwordx4 v[60:63], v5, s[40:43], s11 offen sc1
  s_cmp_lg_u32 s7, 0
  s_cbranch_scc1 L_rl_done_58
  s_waitcnt vmcnt(12)
  ds_read_b64_tr_b16 v[64:65], v4 offset:12288
  ds_read_b64_tr_b16 v[66:67], v4 offset:12800
  ds_read_b64_tr_b16 v[68:69], v4 offset:12320
  ds_read_b64_tr_b16 v[70:71], v4 offset:12832
  ds_read_b64_tr_b16 v[72:73], v4 offset:12352
  ds_read_b64_tr_b16 v[74:75], v4 offset:12864
  ds_read_b64_tr_b16 v[76:77], v4 offset:12384
  ds_read_b64_tr_b16 v[78:79], v4 offset:12896
  s_add_u32 s11, s9, 3072
  s_waitcnt lgkmcnt(6)
  buffer_store_dwordx4 v[64:67], v5, s[40:43], s11 offen sc1
  s_add_u32 s11, s9, 17408
  s_waitcnt lgkmcnt(4)
  buffer_store_dwordx4 v[68:71], v5, s[40:43], s11 offen sc1
  s_add_u32 s11, s9, 31744
  s_waitcnt lgkmcnt(2)
  buffer_store_dwordx4 v[72:75], v5, s[40:43], s11 offen sc1
  s_add_u32 s11, s9, 46080
  s_waitcnt lgkmcnt(0)
  buffer_store_dwordx4 v[76:79], v5, s[40:43], s11 offen sc1
L_rl_done_58:
  v_mov_b32 v242, 0
  s_cmp_lg_u32 s3, 0
  s_cbranch_scc1 L_gn_59
  buffer_load_dword v243, v242, s[72:75], 0 offen sc1
L_gn_59:
  s_cmp_lg_u32 s3, 0
  s_cbranch_scc1 L_gn_60
  s_mov_b32 s77, 0
  s_branch L_pchk_63
L_poll_61:
  buffer_load_dword v243, v242, s[72:75], 0 offen sc1
L_pchk_63:
  s_add_u32 s77, s77, 1
  s_waitcnt vmcnt(0)
  v_cmp_eq_u32 vcc, 0, v243
  s_cmp_ge_u32 s77, 400000
  s_cbranch_scc1 L_pdone_62
  s_cbranch_vccnz L_poll_61
L_pdone_62:
  v_readfirstlane_b32 s70, v243
  s_lshl_b32 s76, s4, 4
  s_add_u32 s76, s76, s5
  s_lshl_b32 s76, s76, 4
  s_add_u32 s76, s76, 37801984
  v_or_b32 v243, s68, v243
  v_cmp_eq_u32 vcc, 0, v0
  v_mov_b32 v244, 0x7ffffff0
  s_nop 0
  v_cndmask_b32 v242, v244, 0, vcc
  buffer_store_dword v243, v242, s[40:43], s76 offen sc1
  v_mov_b32 v244, 83712
  v_mov_b32 v248, 0
  v_mov_b32 v249, s70
  ds_write_b64 v244, v[248:249]
L_gn_60:
  s_waitcnt lgkmcnt(0)
  s_barrier
  v_mov_b32 v244, 83712
  ds_read_b64 v[248:249], v244
  s_waitcnt lgkmcnt(0)
  v_readfirstlane_b32 s67, v248
  v_readfirstlane_b32 s70, v249
  v_mov_b32 v245, v249
  s_waitcnt vmcnt(0) lgkmcnt(0)
  s_barrier
  s_cmp_lg_u32 s3, 0
  s_cbranch_scc1 L_arr_64
  s_lshl_b32 s76, s4, 4
  s_add_u32 s76, s76, s5
  s_lshl_b32 s76, s76, 2
  v_cmp_eq_u32 vcc, 0, v0
  v_mov_b32 v244, 0x7ffffff0
  s_nop 0
  v_cndmask_b32 v242, v244, 0, vcc
  s_add_u32 s77, s76, 37797888
  buffer_store_dword v245, v242, s[40:43], s77 offen sc1
L_arr_64:
  s_lshl_b32 s6, s3, 8
  s_or_b32 s6, s6, s2
  s_cmp_lg_u32 s6, 7
  s_cbranch_scc1 L_wl_65
  s_mov_b32 s76, 37798784
  v_and_b32 v242, 31, v0
  v_lshlrev_b32 v242, 2, v242
  s_mov_b32 s77, 0
L_poll_66:
  buffer_load_dword v243, v242, s[40:43], s76 offen sc1
  s_add_u32 s77, s77, 1
  s_waitcnt vmcnt(0)
  v_cmp_ne_u32 vcc, s70, v243
  s_cmp_ge_u32 s77, 400000
  s_cbranch_scc1 L_pdone_67
  s_cbranch_vccnz L_poll_66
L_pdone_67:
  s_mov_b32 s76, 37810304
  v_cmp_eq_u32 vcc, 0, v0
  v_mov_b32 v244, 0x7ffffff0
  s_nop 0
  v_cndmask_b32 v242, v244, 0, vcc
  buffer_store_dword v245, v242, s[40:43], s76 offen sc1
L_wl_65:
  s_lshr_b32 s88, s2, 3
  s_lshl_b32 s88, s88, 2
  s_add_u32 s88, s88, s3
  s_cmp_ge_u32 s88, 112
  s_cbranch_scc1 L_rl_done_68
  s_lshl_b32 s91, s3, 14
  s_mov_b32 s6, 0
  v_lshrrev_b32 v12, 3, v0
  v_and_b32 v13, 7, v0
  v_lshlrev_b32 v13, 4, v13
  v_lshlrev_b32 v5, 4, v0
  v_bfe_u32 v6, v0, 2, 2
  v_lshlrev_b32 v4, 7, v6
  v_and_b32 v6, 3, v0
  v_lshl_add_u32 v4, v6, 3, v4
  v_add_u32 v4, s91, v4
  s_mov_b32 s80, s32
  s_mov_b32 s81, s33
  s_mov_b32 s82, 0x188000
  s_mov_b32 s83, 0x20000
  s_lshr_b32 s89, s88, 4
  s_bfe_u32 s90, s88, 0x30001
  s_mul_i32 s90, s90, 7
  s_and_b32 s7, s88, 1
  s_lshl_b32 s6, s7, 2
  s_add_u32 s90, s90, s6
  v_lshrrev_b32 v6, 5, v0
  v_lshl_add_u32 v4, v6, 10, v4
  v_bfe_u32 v6, v0, 4, 1
  v_lshl_add_u32 v4, v6, 5, v4
  s_mul_i32 s9, s89, 229376
  s_lshl_b32 s11, s90, 12
  s_add_u32 s9, s9, s11
  s_add_u32 s9, s9, 35651584
  s_lshl_b32 s10, s89, 7
  s_mul_i32 s11, s90, 28672
  s_add_u32 s10, s10, s11
  v_mul_u32_u24 v14, 896, v12
  v_add_u32 v14, v14, v13
  s_add_u32 m0, s91, 0
  s_add_u32 s11, s10, 0
  buffer_load_dwordx4 v14, s[80:83], s11 offen lds
  s_add_u32 m0, s91, 1024
  s_add_u32 s11, s10, 7168
  buffer_load_dwordx4 v14, s[80:83], s11 offen lds
  s_add_u32 m0, s91, 2048
  s_add_u32 s11, s10, 14336
  buffer_load_dwordx4 v14, s[80:83], s11 offen lds
  s_add_u32 m0, s91, 3072
  s_add_u32 s11, s10, 21504
  buffer_load_dwordx4 v14, s[80:83], s11 offen lds
  s_add_u32 m0, s91, 4096
  s_add_u32 s11, s10, 28672
  buffer_load_dwordx4 v14, s[80:83], s11 offen lds
  s_add_u32 m0, s91, 5120
  s_add_u32 s11, s10, 35840
  buffer_load_dwordx4 v14, s[80:83], s11 offen lds
  s_add_u32 m0, s91, 6144
  s_add_u32 s11, s10, 43008
  buffer_load_dwordx4 v14, s[80:83], s11 offen lds
  s_add_u32 m0, s91, 7168
  s_add_u32 s11, s10, 50176
  buffer_load_dwordx4 v14, s[80:83], s11 offen lds
  s_add_u32 m0, s91, 8192
  s_add_u32 s11, s10, 57344
  buffer_load_dwordx4 v14, s[80:83], s11 offen lds
  s_add_u32 m0, s91, 9216
  s_add_u32 s11, s10, 64512
  buffer_load_dwordx4 v14, s[80:83], s11 offen lds
  s_add_u32 m0, s91, 10240
  s_add_u32 s11, s10, 71680
  buffer_load_dwordx4 v14, s[80:83], s11 offen lds
  s_add_u32 m0, s91, 11264
  s_add_u32 s11, s10, 78848
  buffer_load_dwordx4 v14, s[80:83], s11 offen lds
  s_add_u32 m0, s91, 12288
  s_add_u32 s11, s10, 86016
  buffer_load_dwordx4 v14, s[80:83], s11 offen lds
  s_add_u32 m0, s91, 13312
  s_add_u32 s11, s10, 93184
  buffer_load_dwordx4 v14, s[80:83], s11 offen lds
  s_add_u32 m0, s91, 14336
  s_add_u32 s11, s10, 100352
  buffer_load_dwordx4 v14, s[80:83], s11 offen lds
  s_add_u32 m0, s91, 15360
  s_add_u32 s11, s10, 107520
  buffer_load_dwordx4 v14, s[80:83], s11 offen lds
  s_waitcnt vmcnt(12)
  ds_read_b64_tr_b16 v[16:17], v4 offset:0
  ds_read_b64_tr_b16 v[18:19], v4 offset:512
  ds_read_b64_tr_b16 v[20:21], v4 offset:64
  ds_read_b64_tr_b16 v[22:23], v4 offset:576
  ds_read_b64_tr_b16 v[24:25], v4 offset:2048
  ds_read_b64_tr_b16 v[26:27], v4 offset:2560
  ds_read_b64_tr_b16 v[28:29], v4 offset:2112
  ds_read_b64_tr_b16 v[30:31], v4 offset:2624
  s_add_u32 s11, s9, 0
  s_waitcnt lgkmcnt(6)
  buffer_store_dwordx4 v[16:19], v5, s[40:43], s11 offen sc1
  s_add_u32 s11, s9, 1024
  s_waitcnt lgkmcnt(4)
  buffer_store_dwordx4 v[20:23], v5, s[40:43], s11 offen sc1
  s_add_u32 s11, s9, 2048
  s_waitcnt lgkmcnt(2)
  buffer_store_dwordx4 v[24:27], v5, s[40:43], s11 offen sc1
  s_add_u32 s11, s9, 3072
  s_waitcnt lgkmcnt(0)
  buffer_store_dwordx4 v[28:31], v5, s[40:43], s11 offen sc1
  s_waitcnt vmcnt(12)
  ds_read_b64_tr_b16 v[32:33], v4 offset:4096
  ds_read_b64_tr_b16 v[34:35], v4 offset:4608
  ds_read_b64_tr_b16 v[36:37], v4 offset:4160
  ds_read_b64_tr_b16 v[38:39], v4 offset:4672
  ds_read_b64_tr_b16 v[40:41], v4 offset:6144
  ds_read_b64_tr_b16 v[42:43], v4 offset:6656
  ds_read_b64_tr_b16 v[44:45], v4 offset:6208
  ds_read_b64_tr_b16 v[46:47], v4 offset:6720
  s_add_u32 s11, s9, 4096
  s_waitcnt lgkmcnt(6)
  buffer_store_dwordx4 v[32:35], v5, s[40:43], s11 offen sc1
  s_add_u32 s11, s9, 5120
  s_waitcnt lgkmcnt(4)
  buffer_store_dwordx4 v[36:39], v5, s[40:43], s11 offen sc1
  s_add_u32 s11, s9, 6144
  s_waitcnt lgkmcnt(2)
  buffer_store_dwordx4 v[40:43], v5, s[40:43], s11 offen sc1
  s_add_u32 s11, s9, 7168
  s_waitcnt lgkmcnt(0)
  buffer_store_dwordx4 v[44:47], v5, s[40:43], s11 offen sc1
  s_waitcnt vmcnt(12)
  ds_read_b64_tr_b16 v[48:49], v4 offset:8192
  ds_read_b64_tr_b16 v[50:51], v4 offset:8704
  ds_read_b64_tr_b16 v[52:53], v4 offset:8256
  ds_read_b64_tr_b16 v[54:55], v4 offset:8768
  ds_read_b64_tr_b16 v[56:57], v4 offset:10240
  ds_read_b64_tr_b16 v[58:59], v4 offset:10752
  ds_read_b64_tr_b16 v[60:61], v4 offset:10304
  ds_read_b64_tr_b16 v[62:63], v4 offset:10816
  s_add_u32 s11, s9, 8192
  s_waitcnt lgkmcnt(6)
  buffer_store_dwordx4 v[48:51], v5, s[40:43], s11 offen sc1
  s_add_u32 s11, s9, 9216
  s_waitcnt lgkmcnt(4)
  buffer_store_dwordx4 v[52:55], v5, s[40:43], s11 offen sc1
  s_add_u32 s11, s9, 10240
  s_waitcnt lgkmcnt(2)
  buffer_store_dwordx4 v[56:59], v5, s[40:43], s11 offen sc1
  s_add_u32 s11, s9, 11264
  s_waitcnt lgkmcnt(0)
  buffer_store_dwordx4 v[60:63], v5, s[40:43], s11 offen sc1
  s_cmp_lg_u32 s7, 0
  s_cbranch_scc1 L_rl_done_68
  s_waitcnt vmcnt(12)
  ds_read_b64_tr_b16 v[64:65], v4 offset:12288
  ds_read_b64_tr_b16 v[66:67], v4 offset:12800
  ds_read_b64_tr_b16 v[68:69], v4 offset:12352
  ds_read_b64_tr_b16 v[70:71], v4 offset:12864
  ds_read_b64_tr_b16 v[72:73], v4 offset:14336
  ds_read_b64_tr_b16 v[74:75], v4 offset:14848
  ds_read_b64_tr_b16 v[76:77], v4 offset:14400
  ds_read_b64_tr_b16 v[78:79], v4 offset:14912
  s_add_u32 s11, s9, 12288
  s_waitcnt lgkmcnt(6)
  buffer_store_dwordx4 v[64:67], v5, s[40:43], s11 offen sc1
  s_add_u32 s11, s9, 13312
  s_waitcnt lgkmcnt(4)
  buffer_store_dwordx4 v[68:71], v5, s[40:43], s11 offen sc1
  s_add_u32 s11, s9, 14336
  s_waitcnt lgkmcnt(2)
  buffer_store_dwordx4 v[72:75], v5, s[40:43], s11 offen sc1
  s_add_u32 s11, s9, 15360
  s_waitcnt lgkmcnt(0)
  buffer_store_dwordx4 v[76:79], v5, s[40:43], s11 offen sc1
L_rl_done_68:
  s_mov_b32 s52, s16
  s_mov_b32 s53, s17
  s_mov_b32 s54, 0x1c0000
  s_mov_b32 s55, 0x20000
  buffer_load_dwordx4 v[192:195], v200, s[52:55], 0 offen
  buffer_load_dwordx4 v[196:199], v200, s[52:55], 0 offen offset:896
  s_waitcnt vmcnt(0) lgkmcnt(0)
  s_barrier
  s_cmp_lg_u32 s3, 0
  s_cbranch_scc1 L_arr_69
  s_lshl_b32 s76, s4, 4
  s_add_u32 s76, s76, s5
  s_lshl_b32 s76, s76, 2
  v_cmp_eq_u32 vcc, 0, v0
  v_mov_b32 v244, 0x7ffffff0
  s_nop 0
  v_cndmask_b32 v242, v244, 0, vcc
  s_add_u32 s77, s76, 37793792
  buffer_store_dword v245, v242, s[40:43], s77 offen sc1
L_arr_69:
  s_lshl_b32 s6, s3, 8
  s_or_b32 s6, s6, s2
  s_cmp_lg_u32 s6, 7
  s_cbranch_scc1 L_wl_70
  s_mov_b32 s76, 37794688
  v_and_b32 v242, 31, v0
  v_lshlrev_b32 v242, 2, v242
  s_mov_b32 s77, 0
L_poll_71:
  buffer_load_dword v243, v242, s[40:43], s76 offen sc1
  s_add_u32 s77, s77, 1
  s_waitcnt vmcnt(0)
  v_cmp_ne_u32 vcc, s70, v243
  s_cmp_ge_u32 s77, 400000
  s_cbranch_scc1 L_pdone_72
  s_cbranch_vccnz L_poll_71
L_pdone_72:
  s_mov_b32 s76, 37810432
  v_cmp_eq_u32 vcc, 0, v0
  v_mov_b32 v244, 0x7ffffff0
  s_nop 0
  v_cndmask_b32 v242, v244, 0, vcc
  buffer_store_dword v245, v242, s[40:43], s76 offen sc1
L_wl_70:
  s_cmp_lg_u32 s3, 1
  s_cbranch_scc1 L_xc_73
  s_and_b32 s76, s2, 7
  s_lshl_b32 s76, s76, 9
  s_add_u32 s76, s76, 37801984
  v_and_b32 v242, 31, v0
  v_lshlrev_b32 v242, 4, v242
  s_mov_b32 s77, 0
L_poll_74:
  buffer_load_dword v243, v242, s[40:43], s76 offen sc1
  s_add_u32 s77, s77, 1
  s_waitcnt vmcnt(0)
  v_xor_b32 v244, s70, v243
  v_cmp_lt_u32 vcc, 7, v244
  s_cmp_ge_u32 s77, 400000
  s_cbranch_scc1 L_pdone_75
  s_cbranch_vccnz L_poll_74
L_pdone_75:
  s_or_b32 s10, s70, s68
  v_cmp_ne_u32 vcc, s10, v243
  v_mov_b32 v244, 100352
  v_mov_b32 v249, s70
  s_cmp_eq_u64 vcc, 0
  s_cselect_b32 s10, 1, 0
  v_mov_b32 v248, s10
  ds_write_b64 v244, v[248:249]
L_xc_73:
  v_lshlrev_b32 v119, 4, v0
  s_cmp_eq_u32 s3, 0
  s_cbranch_scc1 L_nw0_76
  s_sub_u32 s92, s3, 1
  s_lshl_b32 s92, s92, 10
  s_mul_i32 s94, s5, 100352
  s_add_u32 s94, s94, 33554432
  s_add_u32 s94, s94, s92
  s_mov_b32 s76, 37810304
  v_mov_b32 v242, 0
  s_mov_b32 s77, 0
L_poll_77:
  s_sleep 8
  buffer_load_dword v243, v242, s[40:43], s76 offen sc1
  s_add_u32 s77, s77, 1
  s_waitcnt vmcnt(0)
  v_cmp_ne_u32 vcc, s70, v243
  s_cmp_ge_u32 s77, 400000
  s_cbranch_scc1 L_pdone_78
  s_cbranch_vccnz L_poll_77
L_pdone_78:
  s_add_u32 m0, s92, 0
  s_add_u32 s93, s94, 0
  buffer_load_dwordx4 v119, s[40:43], s93 offen lds
  s_add_u32 m0, s92, 3072
  s_add_u32 s93, s94, 3072
  buffer_load_dwordx4 v119, s[40:43], s93 offen lds
  s_add_u32 m0, s92, 6144
  s_add_u32 s93, s94, 6144
  buffer_load_dwordx4 v119, s[40:43], s93 offen lds
  s_add_u32 m0, s92, 9216
  s_add_u32 s93, s94, 9216
  buffer_load_dwordx4 v119, s[40:43], s93 offen lds
  s_add_u32 m0, s92, 12288
  s_add_u32 s93, s94, 12288
  buffer_load_dwordx4 v119, s[40:43], s93 offen lds
  s_add_u32 m0, s92, 15360
  s_add_u32 s93, s94, 15360
  buffer_load_dwordx4 v119, s[40:43], s93 offen lds
  s_add_u32 m0, s92, 18432
  s_add_u32 s93, s94, 18432
  buffer_load_dwordx4 v119, s[40:43], s93 offen lds
  s_add_u32 m0, s92, 21504
  s_add_u32 s93, s94, 21504
  buffer_load_dwordx4 v119, s[40:43], s93 offen lds
  s_add_u32 m0, s92, 24576
  s_add_u32 s93, s94, 24576
  buffer_load_dwordx4 v119, s[40:43], s93 offen lds
  s_add_u32 m0, s92, 27648
  s_add_u32 s93, s94, 27648
  buffer_load_dwordx4 v119, s[40:43], s93 offen lds
  s_add_u32 m0, s92, 30720
  s_add_u32 s93, s94, 30720
  buffer_load_dwordx4 v119, s[40:43], s93 offen lds
  s_add_u32 m0, s92, 33792
  s_add_u32 s93, s94, 33792
  buffer_load_dwordx4 v119, s[40:43], s93 offen lds
  s_add_u32 m0, s92, 36864
  s_add_u32 s93, s94, 36864
  buffer_load_dwordx4 v119, s[40:43], s93 offen lds
  s_add_u32 m0, s92, 39936
  s_add_u32 s93, s94, 39936
  buffer_load_dwordx4 v119, s[40:43], s93 offen lds
  s_add_u32 m0, s92, 43008
  s_add_u32 s93, s94, 43008
  buffer_load_dwordx4 v119, s[40:43], s93 offen lds
  s_add_u32 m0, s92, 46080
  s_add_u32 s93, s94, 46080
  buffer_load_dwordx4 v119, s[40:43], s93 offen lds
  s_add_u32 m0, s92, 49152
  s_add_u32 s93, s94, 49152
  buffer_load_dwordx4 v119, s[40:43], s93 offen lds
  s_add_u32 m0, s92, 52224
  s_add_u32 s93, s94, 52224
  buffer_load_dwordx4 v119, s[40:43], s93 offen lds
  s_add_u32 m0, s92, 55296
  s_add_u32 s93, s94, 55296
  buffer_load_dwordx4 v119, s[40:43], s93 offen lds
  s_add_u32 m0, s92, 58368
  s_add_u32 s93, s94, 58368
  buffer_load_dwordx4 v119, s[40:43], s93 offen lds
  s_add_u32 m0, s92, 61440
  s_add_u32 s93, s94, 61440
  buffer_load_dwordx4 v119, s[40:43], s93 offen lds
  s_add_u32 m0, s92, 64512
  s_add_u32 s93, s94, 64512
  buffer_load_dwordx4 v119, s[40:43], s93 offen lds
  s_add_u32 m0, s92, 67584
  s_add_u32 s93, s94, 67584
  buffer_load_dwordx4 v119, s[40:43], s93 offen lds
  s_add_u32 m0, s92, 70656
  s_add_u32 s93, s94, 70656
  buffer_load_dwordx4 v119, s[40:43], s93 offen lds
L_nw0_76:
L_join_3:
  s_cmp_eq_u32 s3, 0
  s_cbranch_scc1 L_nw0_79
  s_mov_b32 s6, 6291456
  buffer_load_dword v254, v247, s[40:43], s6 offen sc1
  v_min_u32 v44, 55, v0
  v_lshlrev_b32 v44, 7, v44
  s_lshl_b32 s6, s66, 3
  s_mul_i32 s6, s6, 896
  s_add_u32 s6, s6, 12582912
  buffer_load_dword v254, v44, s[40:43], s6 offen sc1
  s_getpc_b64 s[80:81]
L_pc_80:
  s_mov_b32 s82, L_end-L_pc_80
  s_mov_b32 s83, 0x20000
  s_lshr_b32 s7, s2, 3
  s_lshl_b32 s7, s7, 2
  s_add_u32 s7, s7, s3
  s_lshl_b32 s7, s7, 10
  v_lshlrev_b32 v2, 4, v0
  buffer_load_dword v254, v2, s[80:83], s7 offen
L_nw0_79:
  v_lshlrev_b32 v210, 16, v192
  v_and_b32 v211, s12, v192
  v_lshlrev_b32 v212, 16, v193
  v_and_b32 v213, s12, v193
  v_lshlrev_b32 v214, 16, v194
  v_and_b32 v215, s12, v194
  v_lshlrev_b32 v216, 16, v195
  v_and_b32 v217, s12, v195
  v_lshlrev_b32 v218, 16, v196
  v_and_b32 v219, s12, v196
  v_lshlrev_b32 v220, 16, v197
  v_and_b32 v221, s12, v197
  v_lshlrev_b32 v222, 16, v198
  v_and_b32 v223, s12, v198
  v_lshlrev_b32 v224, 16, v199
  v_and_b32 v225, s12, v199
  s_nop 0
  v_readfirstlane_b32 s56, v210
  v_readfirstlane_b32 s57, v210
  v_readfirstlane_b32 s58, v218
  v_readfirstlane_b32 s59, v218
  s_mov_b32 s64, 0x3b124925
  v_pk_add_f32 v[226:227], v[210:211], s[56:57] neg_lo:[0,1] neg_hi:[0,1]
  v_pk_add_f32 v[228:229], v[212:213], s[56:57] neg_lo:[0,1] neg_hi:[0,1]
  v_pk_add_f32 v[230:231], v[214:215], s[56:57] neg_lo:[0,1] neg_hi:[0,1]
  v_pk_add_f32 v[232:233], v[216:217], s[56:57] neg_lo:[0,1] neg_hi:[0,1]
  v_pk_add_f32 v[234:235], v[218:219], s[58:59] neg_lo:[0,1] neg_hi:[0,1]
  v_pk_add_f32 v[236:237], v[220:221], s[58:59] neg_lo:[0,1] neg_hi:[0,1]
  v_pk_add_f32 v[238:239], v[222:223], s[58:59] neg_lo:[0,1] neg_hi:[0,1]
  v_pk_add_f32 v[240:241], v[224:225], s[58:59] neg_lo:[0,1] neg_hi:[0,1]
  v_pk_add_f32 v[20:21], v[226:227], v[228:229]
  v_pk_mul_f32 v[22:23], v[226:227], v[226:227]
  v_pk_add_f32 v[20:21], v[20:21], v[230:231]
  v_pk_add_f32 v[20:21], v[20:21], v[232:233]
  v_pk_fma_f32 v[22:23], v[228:229], v[228:229], v[22:23]
  v_pk_fma_f32 v[22:23], v[230:231], v[230:231], v[22:23]
  v_pk_fma_f32 v[22:23], v[232:233], v[232:233], v[22:23]
  v_pk_add_f32 v[24:25], v[234:235], v[236:237]
  v_pk_mul_f32 v[26:27], v[234:235], v[234:235]
  v_pk_add_f32 v[24:25], v[24:25], v[238:239]
  v_pk_add_f32 v[24:25], v[24:25], v[240:241]
  v_pk_fma_f32 v[26:27], v[236:237], v[236:237], v[26:27]
  v_pk_fma_f32 v[26:27], v[238:239], v[238:239], v[26:27]
  v_pk_fma_f32 v[26:27], v[240:241], v[240:241], v[26:27]
  v_add_f32 v20, v20, v21
  v_add_f32 v21, v22, v23
  v_add_f32 v24, v24, v25
  v_add_f32 v25, v26, v27
  v_mul_f32 v20, v201, v20
  v_mul_f32 v21, v201, v21
  v_mul_f32 v24, v201, v24
  v_mul_f32 v25, v201, v25
  v_add_f32_dpp v20, v20, v20 quad_perm:[1,0,3,2] row_mask:0xf bank_mask:0xf
  v_add_f32_dpp v21, v21, v21 quad_perm:[1,0,3,2] row_mask:0xf bank_mask:0xf
  v_add_f32_dpp v24, v24, v24 quad_perm:[1,0,3,2] row_mask:0xf bank_mask:0xf
  v_add_f32_dpp v25, v25, v25 quad_perm:[1,0,3,2] row_mask:0xf bank_mask:0xf
  v_add_f32_dpp v20, v20, v20 quad_perm:[2,3,0,1] row_mask:0xf bank_mask:0xf
  v_add_f32_dpp v21, v21, v21 quad_perm:[2,3,0,1] row_mask:0xf bank_mask:0xf
  v_add_f32_dpp v24, v24, v24 quad_perm:[2,3,0,1] row_mask:0xf bank_mask:0xf
  v_add_f32_dpp v25, v25, v25 quad_perm:[2,3,0,1] row_mask:0xf bank_mask:0xf
  v_add_f32_dpp v20, v20, v20 row_half_mirror row_mask:0xf bank_mask:0xf
  v_add_f32_dpp v21, v21, v21 row_half_mirror row_mask:0xf bank_mask:0xf
  v_add_f32_dpp v24, v24, v24 row_half_mirror row_mask:0xf bank_mask:0xf
  v_add_f32_dpp v25, v25, v25 row_half_mirror row_mask:0xf bank_mask:0xf
  v_add_f32_dpp v20, v20, v20 row_mirror row_mask:0xf bank_mask:0xf
  v_add_f32_dpp v21, v21, v21 row_mirror row_mask:0xf bank_mask:0xf
  v_add_f32_dpp v24, v24, v24 row_mirror row_mask:0xf bank_mask:0xf
  v_add_f32_dpp v25, v25, v25 row_mirror row_mask:0xf bank_mask:0xf
  v_add_f32_dpp v20, v20, v20 row_bcast:15 row_mask:0xa bank_mask:0xf
  v_add_f32_dpp v21, v21, v21 row_bcast:15 row_mask:0xa bank_mask:0xf
  v_add_f32_dpp v24, v24, v24 row_bcast:15 row_mask:0xa bank_mask:0xf
  v_add_f32_dpp v25, v25, v25 row_bcast:15 row_mask:0xa bank_mask:0xf
  v_add_f32_dpp v20, v20, v20 row_bcast:31 row_mask:0xc bank_mask:0xf
  v_add_f32_dpp v21, v21, v21 row_bcast:31 row_mask:0xc bank_mask:0xf
  v_add_f32_dpp v24, v24, v24 row_bcast:31 row_mask:0xc bank_mask:0xf
  v_add_f32_dpp v25, v25, v25 row_bcast:31 row_mask:0xc bank_mask:0xf
  v_readlane_b32 s60, v20, 63
  v_readlane_b32 s61, v21, 63
  v_readlane_b32 s62, v24, 63
  v_readlane_b32 s63, v25, 63
  v_mov_b32 v28, s64
  v_mul_f32 v20, s60, v28
  v_mul_f32 v21, s62, v28
  v_mul_f32 v22, s61, v28
  v_mul_f32 v23, s63, v28
  v_pk_fma_f32 v[22:23], v[20:21], v[20:21], v[22:23] neg_lo:[1,0,0] neg_hi:[1,0,0]
  v_add_f32 v20, s56, v20
  v_add_f32 v21, s58, v21
  v_max_f32 v22, 0, v22
  v_max_f32 v23, 0, v23
  v_cvt_pk_bf16_f32 v20, v20, v21
  v_and_b32 v21, s12, v20
  v_lshlrev_b32 v20, 16, v20
  v_cvt_pk_bf16_f32 v22, v22, v23
  v_and_b32 v23, s12, v22
  v_lshlrev_b32 v22, 16, v22
  v_add_f32 v22, 0x3727c5ac, v22
  v_add_f32 v23, 0x3727c5ac, v23
  v_cvt_pk_bf16_f32 v22, v22, v23
  v_and_b32 v23, s12, v22
  v_lshlrev_b32 v22, 16, v22
  v_sqrt_f32 v22, v22
  v_sqrt_f32 v23, v23
  v_pk_add_f32 v[226:227], v[210:211], v[20:21] op_sel_hi:[1,0] neg_lo:[0,1] neg_hi:[0,1]
  v_pk_add_f32 v[228:229], v[212:213], v[20:21] op_sel_hi:[1,0] neg_lo:[0,1] neg_hi:[0,1]
  v_pk_add_f32 v[230:231], v[214:215], v[20:21] op_sel_hi:[1,0] neg_lo:[0,1] neg_hi:[0,1]
  v_pk_add_f32 v[232:233], v[216:217], v[20:21] op_sel_hi:[1,0] neg_lo:[0,1] neg_hi:[0,1]
  v_cvt_pk_bf16_f32 v22, v22, v23
  v_and_b32 v23, s12, v22
  v_lshlrev_b32 v22, 16, v22
  v_rcp_f32 v24, v22
  v_rcp_f32 v25, v23
  v_pk_add_f32 v[234:235], v[218:219], v[20:21] op_sel:[0,1] op_sel_hi:[1,1] neg_lo:[0,1] neg_hi:[0,1]
  v_pk_add_f32 v[236:237], v[220:221], v[20:21] op_sel:[0,1] op_sel_hi:[1,1] neg_lo:[0,1] neg_hi:[0,1]
  v_pk_add_f32 v[238:239], v[222:223], v[20:21] op_sel:[0,1] op_sel_hi:[1,1] neg_lo:[0,1] neg_hi:[0,1]
  v_pk_add_f32 v[240:241], v[224:225], v[20:21] op_sel:[0,1] op_sel_hi:[1,1] neg_lo:[0,1] neg_hi:[0,1]
  v_fma_f32 v26, -v22, v24, 1.0
  v_fma_f32 v27, -v23, v25, 1.0
  v_pk_fma_f32 v[24:25], v[26:27], v[24:25], v[24:25]
  v_cvt_pk_bf16_f32 v226, v226, v227
  v_and_b32 v227, s12, v226
  v_lshlrev_b32 v226, 16, v226
  v_pk_mul_f32 v[226:227], v[226:227], v[24:25] op_sel_hi:[1,0]
  v_cvt_pk_bf16_f32 v226, v226, v227
  v_and_b32 v227, s12, v226
  v_lshlrev_b32 v226, 16, v226
  v_cvt_pk_bf16_f32 v228, v228, v229
  v_and_b32 v229, s12, v228
  v_lshlrev_b32 v228, 16, v228
  v_pk_mul_f32 v[228:229], v[228:229], v[24:25] op_sel_hi:[1,0]
  v_cvt_pk_bf16_f32 v228, v228, v229
  v_and_b32 v229, s12, v228
  v_lshlrev_b32 v228, 16, v228
  v_cvt_pk_bf16_f32 v230, v230, v231
  v_and_b32 v231, s12, v230
  v_lshlrev_b32 v230, 16, v230
  v_pk_mul_f32 v[230:231], v[230:231], v[24:25] op_sel_hi:[1,0]
  v_cvt_pk_bf16_f32 v230, v230, v231
  v_and_b32 v231, s12, v230
  v_lshlrev_b32 v230, 16, v230
  v_cvt_pk_bf16_f32 v232, v232, v233
  v_and_b32 v233, s12, v232
  v_lshlrev_b32 v232, 16, v232
  v_pk_mul_f32 v[232:233], v[232:233], v[24:25] op_sel_hi:[1,0]
  v_cvt_pk_bf16_f32 v232, v232, v233
  v_and_b32 v233, s12, v232
  v_lshlrev_b32 v232, 16, v232
  v_cvt_pk_bf16_f32 v234, v234, v235
  v_and_b32 v235, s12, v234
  v_lshlrev_b32 v234, 16, v234
  v_pk_mul_f32 v[234:235], v[234:235], v[24:25] op_sel:[0,1] op_sel_hi:[1,1]
  v_cvt_pk_bf16_f32 v234, v234, v235
  v_and_b32 v235, s12, v234
  v_lshlrev_b32 v234, 16, v234
  v_cvt_pk_bf16_f32 v236, v236, v237
  v_and_b32 v237, s12, v236
  v_lshlrev_b32 v236, 16, v236
  v_pk_mul_f32 v[236:237], v[236:237], v[24:25] op_sel:[0,1] op_sel_hi:[1,1]
  v_cvt_pk_bf16_f32 v236, v236, v237
  v_and_b32 v237, s12, v236
  v_lshlrev_b32 v236, 16, v236
  v_cvt_pk_bf16_f32 v238, v238, v239
  v_and_b32 v239, s12, v238
  v_lshlrev_b32 v238, 16, v238
  v_pk_mul_f32 v[238:239], v[238:239], v[24:25] op_sel:[0,1] op_sel_hi:[1,1]
  v_cvt_pk_bf16_f32 v238, v238, v239
  v_and_b32 v239, s12, v238
  v_lshlrev_b32 v238, 16, v238
  v_cvt_pk_bf16_f32 v240, v240, v241
  v_and_b32 v241, s12, v240
  v_lshlrev_b32 v240, 16, v240
  v_pk_mul_f32 v[240:241], v[240:241], v[24:25] op_sel:[0,1] op_sel_hi:[1,1]
  v_cvt_pk_bf16_f32 v240, v240, v241
  v_and_b32 v241, s12, v240
  v_lshlrev_b32 v240, 16, v240
  s_cmp_lg_u32 s3, 0
  s_cbranch_scc1 L_wy_81
  v_min_u32 v242, 55, v0
  v_lshlrev_b32 v242, 4, v242
  s_mov_b32 s76, 37793792
  s_mov_b32 s77, 0
L_poll_82:
  s_sleep 2
  buffer_load_dwordx4 v[248:251], v242, s[40:43], s76 offen sc1
  s_add_u32 s77, s77, 1
  s_waitcnt vmcnt(0)
  v_xor_b32 v248, s70, v248
  v_xor_b32 v249, s70, v249
  v_xor_b32 v250, s70, v250
  v_xor_b32 v251, s70, v251
  v_or3_b32 v248, v248, v249, v250
  v_or_b32 v248, v248, v251
  v_cmp_ne_u32 vcc, 0, v248
  s_cmp_ge_u32 s77, 400000
  s_cbranch_scc1 L_pdone_83
  s_cbranch_vccnz L_poll_82
L_pdone_83:
  s_lshl_b32 s6, s4, 7
  s_lshl_b32 s7, s5, 3
  s_add_u32 s6, s6, s7
  s_lshl_b32 s6, s6, 1
  s_add_u32 s6, s6, 2097152
  v_lshlrev_b32 v2, 12, v0
  s_add_u32 s7, s6, 0
  buffer_load_dwordx4 v[16:19], v2, s[40:43], s7 offen sc1
  s_add_u32 s7, s6, 262144
  buffer_load_dwordx4 v[20:23], v2, s[40:43], s7 offen sc1
  s_add_u32 s7, s6, 524288
  buffer_load_dwordx4 v[24:27], v2, s[40:43], s7 offen sc1
  s_add_u32 s7, s6, 786432
  buffer_load_dwordx4 v[28:31], v2, s[40:43], s7 offen sc1
  s_add_u32 s7, s6, 1048576
  buffer_load_dwordx4 v[32:35], v2, s[40:43], s7 offen sc1
  s_add_u32 s7, s6, 1310720
  buffer_load_dwordx4 v[36:39], v2, s[40:43], s7 offen sc1
  s_add_u32 s7, s6, 1572864
  buffer_load_dwordx4 v[40:43], v2, s[40:43], s7 offen sc1
  v_lshlrev_b32 v3, 2, v0
  v_add_u32 v3, 149504, v3
  s_waitcnt vmcnt(6)
  ds_write_b32 v3, v16 offset:0
  ds_write_b32 v3, v17 offset:1792
  ds_write_b32 v3, v18 offset:3584
  ds_write_b32 v3, v19 offset:5376
  s_waitcnt vmcnt(5)
  ds_write_b32 v3, v20 offset:256
  ds_write_b32 v3, v21 offset:2048
  ds_write_b32 v3, v22 offset:3840
  ds_write_b32 v3, v23 offset:5632
  s_waitcnt vmcnt(4)
  ds_write_b32 v3, v24 offset:512
  ds_write_b32 v3, v25 offset:2304
  ds_write_b32 v3, v26 offset:4096
  ds_write_b32 v3, v27 offset:5888
  s_waitcnt vmcnt(3)
  ds_write_b32 v3, v28 offset:768
  ds_write_b32 v3, v29 offset:2560
  ds_write_b32 v3, v30 offset:4352
  ds_write_b32 v3, v31 offset:6144
  s_waitcnt vmcnt(2)
  ds_write_b32 v3, v32 offset:1024
  ds_write_b32 v3, v33 offset:2816
  ds_write_b32 v3, v34 offset:4608
  ds_write_b32 v3, v35 offset:6400
  s_waitcnt vmcnt(1)
  ds_write_b32 v3, v36 offset:1280
  ds_write_b32 v3, v37 offset:3072
  ds_write_b32 v3, v38 offset:4864
  ds_write_b32 v3, v39 offset:6656
  s_waitcnt vmcnt(0)
  ds_write_b32 v3, v40 offset:1536
  ds_write_b32 v3, v41 offset:3328
  ds_write_b32 v3, v42 offset:5120
  ds_write_b32 v3, v43 offset:6912
L_wy_81:
  s_mul_i32 s6, s3, 1792
  s_add_u32 s6, s6, 149504
  v_min_u32 v3, 55, v0
  v_lshl_add_u32 v3, v3, 5, s6
  s_waitcnt lgkmcnt(0)
  s_barrier
  ds_read_b128 v[202:205], v3
  ds_read_b128 v[206:209], v3 offset:16
  v_cmp_gt_u32 vcc, 56, v0
  v_mov_b32 v244, 100352
  ds_read_b64 v[248:249], v244
  s_waitcnt lgkmcnt(0)
  v_readfirstlane_b32 s67, v248
  v_readfirstlane_b32 s70, v249
  v_mov_b32 v245, v249
  v_cndmask_b32 v202, 0, v202, vcc
  v_cndmask_b32 v203, 0, v203, vcc
  v_cndmask_b32 v204, 0, v204, vcc
  v_cndmask_b32 v205, 0, v205, vcc
  v_cndmask_b32 v206, 0, v206, vcc
  v_cndmask_b32 v207, 0, v207, vcc
  v_cndmask_b32 v208, 0, v208, vcc
  v_cndmask_b32 v209, 0, v209, vcc
  v_lshlrev_b32 v40, 16, v202
  v_lshlrev_b32 v41, 16, v203
  v_lshlrev_b32 v42, 16, v204
  v_lshlrev_b32 v43, 16, v205
  v_lshlrev_b32 v44, 16, v206
  v_lshlrev_b32 v45, 16, v207
  v_lshlrev_b32 v46, 16, v208
  v_lshlrev_b32 v47, 16, v209
  v_pk_mul_f32 v[226:227], v[226:227], v[40:41]
  v_cvt_pk_bf16_f32 v226, v226, v227
  v_and_b32 v227, s12, v226
  v_lshlrev_b32 v226, 16, v226
  v_pk_add_f32 v[210:211], v[210:211], v[226:227]
  v_cvt_pk_bf16_f32 v210, v210, v211
  v_and_b32 v211, s12, v210
  v_lshlrev_b32 v210, 16, v210
  v_pk_mul_f32 v[228:229], v[228:229], v[42:43]
  v_cvt_pk_bf16_f32 v228, v228, v229
  v_and_b32 v229, s12, v228
  v_lshlrev_b32 v228, 16, v228
  v_pk_add_f32 v[212:213], v[212:213], v[228:229]
  v_cvt_pk_bf16_f32 v212, v212, v213
  v_and_b32 v213, s12, v212
  v_lshlrev_b32 v212, 16, v212
  v_pk_mul_f32 v[230:231], v[230:231], v[44:45]
  v_cvt_pk_bf16_f32 v230, v230, v231
  v_and_b32 v231, s12, v230
  v_lshlrev_b32 v230, 16, v230
  v_pk_add_f32 v[214:215], v[214:215], v[230:231]
  v_cvt_pk_bf16_f32 v214, v214, v215
  v_and_b32 v215, s12, v214
  v_lshlrev_b32 v214, 16, v214
  v_pk_mul_f32 v[232:233], v[232:233], v[46:47]
  v_cvt_pk_bf16_f32 v232, v232, v233
  v_and_b32 v233, s12, v232
  v_lshlrev_b32 v232, 16, v232
  v_pk_add_f32 v[216:217], v[216:217], v[232:233]
  v_cvt_pk_bf16_f32 v216, v216, v217
  v_and_b32 v217, s12, v216
  v_lshlrev_b32 v216, 16, v216
  v_and_b32 v40, s12, v202
  v_and_b32 v41, s12, v203
  v_and_b32 v42, s12, v204
  v_and_b32 v43, s12, v205
  v_and_b32 v44, s12, v206
  v_and_b32 v45, s12, v207
  v_and_b32 v46, s12, v208
  v_and_b32 v47, s12, v209
  v_pk_mul_f32 v[234:235], v[234:235], v[40:41]
  v_cvt_pk_bf16_f32 v234, v234, v235
  v_and_b32 v235, s12, v234
  v_lshlrev_b32 v234, 16, v234
  v_pk_add_f32 v[218:219], v[218:219], v[234:235]
  v_cvt_pk_bf16_f32 v218, v218, v219
  v_and_b32 v219, s12, v218
  v_lshlrev_b32 v218, 16, v218
  v_pk_mul_f32 v[236:237], v[236:237], v[42:43]
  v_cvt_pk_bf16_f32 v236, v236, v237
  v_and_b32 v237, s12, v236
  v_lshlrev_b32 v236, 16, v236
  v_pk_add_f32 v[220:221], v[220:221], v[236:237]
  v_cvt_pk_bf16_f32 v220, v220, v221
  v_and_b32 v221, s12, v220
  v_lshlrev_b32 v220, 16, v220
  v_pk_mul_f32 v[238:239], v[238:239], v[44:45]
  v_cvt_pk_bf16_f32 v238, v238, v239
  v_and_b32 v239, s12, v238
  v_lshlrev_b32 v238, 16, v238
  v_pk_add_f32 v[222:223], v[222:223], v[238:239]
  v_cvt_pk_bf16_f32 v222, v222, v223
  v_and_b32 v223, s12, v222
  v_lshlrev_b32 v222, 16, v222
  v_pk_mul_f32 v[240:241], v[240:241], v[46:47]
  v_cvt_pk_bf16_f32 v240, v240, v241
  v_and_b32 v241, s12, v240
  v_lshlrev_b32 v240, 16, v240
  v_pk_add_f32 v[224:225], v[224:225], v[240:241]
  v_cvt_pk_bf16_f32 v224, v224, v225
  v_and_b32 v225, s12, v224
  v_lshlrev_b32 v224, 16, v224
  s_nop 0
  v_readfirstlane_b32 s56, v210
  v_readfirstlane_b32 s57, v210
  v_readfirstlane_b32 s58, v218
  v_readfirstlane_b32 s59, v218
  s_mov_b32 s64, 0x3b124925
  v_pk_add_f32 v[226:227], v[210:211], s[56:57] neg_lo:[0,1] neg_hi:[0,1]
  v_pk_add_f32 v[228:229], v[212:213], s[56:57] neg_lo:[0,1] neg_hi:[0,1]
  v_pk_add_f32 v[230:231], v[214:215], s[56:57] neg_lo:[0,1] neg_hi:[0,1]
  v_pk_add_f32 v[232:233], v[216:217], s[56:57] neg_lo:[0,1] neg_hi:[0,1]
  v_pk_add_f32 v[234:235], v[218:219], s[58:59] neg_lo:[0,1] neg_hi:[0,1]
  v_pk_add_f32 v[236:237], v[220:221], s[58:59] neg_lo:[0,1] neg_hi:[0,1]
  v_pk_add_f32 v[238:239], v[222:223], s[58:59] neg_lo:[0,1] neg_hi:[0,1]
  v_pk_add_f32 v[240:241], v[224:225], s[58:59] neg_lo:[0,1] neg_hi:[0,1]
  v_pk_add_f32 v[20:21], v[226:227], v[228:229]
  v_pk_mul_f32 v[22:23], v[226:227], v[226:227]
  v_pk_add_f32 v[20:21], v[20:21], v[230:231]
  v_pk_add_f32 v[20:21], v[20:21], v[232:233]
  v_pk_fma_f32 v[22:23], v[228:229], v[228:229], v[22:23]
  v_pk_fma_f32 v[22:23], v[230:231], v[230:231], v[22:23]
  v_pk_fma_f32 v[22:23], v[232:233], v[232:233], v[22:23]
  v_pk_add_f32 v[24:25], v[234:235], v[236:237]
  v_pk_mul_f32 v[26:27], v[234:235], v[234:235]
  v_pk_add_f32 v[24:25], v[24:25], v[238:239]
  v_pk_add_f32 v[24:25], v[24:25], v[240:241]
  v_pk_fma_f32 v[26:27], v[236:237], v[236:237], v[26:27]
  v_pk_fma_f32 v[26:27], v[238:239], v[238:239], v[26:27]
  v_pk_fma_f32 v[26:27], v[240:241], v[240:241], v[26:27]
  v_add_f32 v20, v20, v21
  v_add_f32 v21, v22, v23
  v_add_f32 v24, v24, v25
  v_add_f32 v25, v26, v27
  v_mul_f32 v20, v201, v20
  v_mul_f32 v21, v201, v21
  v_mul_f32 v24, v201, v24
  v_mul_f32 v25, v201, v25
  v_add_f32_dpp v20, v20, v20 quad_perm:[1,0,3,2] row_mask:0xf bank_mask:0xf
  v_add_f32_dpp v21, v21, v21 quad_perm:[1,0,3,2] row_mask:0xf bank_mask:0xf
  v_add_f32_dpp v24, v24, v24 quad_perm:[1,0,3,2] row_mask:0xf bank_mask:0xf
  v_add_f32_dpp v25, v25, v25 quad_perm:[1,0,3,2] row_mask:0xf bank_mask:0xf
  v_add_f32_dpp v20, v20, v20 quad_perm:[2,3,0,1] row_mask:0xf bank_mask:0xf
  v_add_f32_dpp v21, v21, v21 quad_perm:[2,3,0,1] row_mask:0xf bank_mask:0xf
  v_add_f32_dpp v24, v24, v24 quad_perm:[2,3,0,1] row_mask:0xf bank_mask:0xf
  v_add_f32_dpp v25, v25, v25 quad_perm:[2,3,0,1] row_mask:0xf bank_mask:0xf
  v_add_f32_dpp v20, v20, v20 row_half_mirror row_mask:0xf bank_mask:0xf
  v_add_f32_dpp v21, v21, v21 row_half_mirror row_mask:0xf bank_mask:0xf
  v_add_f32_dpp v24, v24, v24 row_half_mirror row_mask:0xf bank_mask:0xf
  v_add_f32_dpp v25, v25, v25 row_half_mirror row_mask:0xf bank_mask:0xf
  v_add_f32_dpp v20, v20, v20 row_mirror row_mask:0xf bank_mask:0xf
  v_add_f32_dpp v21, v21, v21 row_mirror row_mask:0xf bank_mask:0xf
  v_add_f32_dpp v24, v24, v24 row_mirror row_mask:0xf bank_mask:0xf
  v_add_f32_dpp v25, v25, v25 row_mirror row_mask:0xf bank_mask:0xf
  v_add_f32_dpp v20, v20, v20 row_bcast:15 row_mask:0xa bank_mask:0xf
  v_add_f32_dpp v21, v21, v21 row_bcast:15 row_mask:0xa bank_mask:0xf
  v_add_f32_dpp v24, v24, v24 row_bcast:15 row_mask:0xa bank_mask:0xf
  v_add_f32_dpp v25, v25, v25 row_bcast:15 row_mask:0xa bank_mask:0xf
  v_add_f32_dpp v20, v20, v20 row_bcast:31 row_mask:0xc bank_mask:0xf
  v_add_f32_dpp v21, v21, v21 row_bcast:31 row_mask:0xc bank_mask:0xf
  v_add_f32_dpp v24, v24, v24 row_bcast:31 row_mask:0xc bank_mask:0xf
  v_add_f32_dpp v25, v25, v25 row_bcast:31 row_mask:0xc bank_mask:0xf
  v_readlane_b32 s60, v20, 63
  v_readlane_b32 s61, v21, 63
  v_readlane_b32 s62, v24, 63
  v_readlane_b32 s63, v25, 63
  v_mov_b32 v28, s64
  v_mul_f32 v20, s60, v28
  v_mul_f32 v21, s62, v28
  v_mul_f32 v22, s61, v28
  v_mul_f32 v23, s63, v28
  v_pk_fma_f32 v[22:23], v[20:21], v[20:21], v[22:23] neg_lo:[1,0,0] neg_hi:[1,0,0]
  v_add_f32 v20, s56, v20
  v_add_f32 v21, s58, v21
  v_max_f32 v22, 0, v22
  v_max_f32 v23, 0, v23
  v_cvt_pk_bf16_f32 v20, v20, v21
  v_and_b32 v21, s12, v20
  v_lshlrev_b32 v20, 16, v20
  v_cvt_pk_bf16_f32 v22, v22, v23
  v_and_b32 v23, s12, v22
  v_lshlrev_b32 v22, 16, v22
  v_add_f32 v22, 0x3727c5ac, v22
  v_add_f32 v23, 0x3727c5ac, v23
  v_cvt_pk_bf16_f32 v22, v22, v23
  v_and_b32 v23, s12, v22
  v_lshlrev_b32 v22, 16, v22
  v_sqrt_f32 v22, v22
  v_sqrt_f32 v23, v23
  v_pk_add_f32 v[226:227], v[210:211], v[20:21] op_sel_hi:[1,0] neg_lo:[0,1] neg_hi:[0,1]
  v_pk_add_f32 v[228:229], v[212:213], v[20:21] op_sel_hi:[1,0] neg_lo:[0,1] neg_hi:[0,1]
  v_pk_add_f32 v[230:231], v[214:215], v[20:21] op_sel_hi:[1,0] neg_lo:[0,1] neg_hi:[0,1]
  v_pk_add_f32 v[232:233], v[216:217], v[20:21] op_sel_hi:[1,0] neg_lo:[0,1] neg_hi:[0,1]
  v_cvt_pk_bf16_f32 v22, v22, v23
  v_and_b32 v23, s12, v22
  v_lshlrev_b32 v22, 16, v22
  v_rcp_f32 v24, v22
  v_rcp_f32 v25, v23
  v_pk_add_f32 v[234:235], v[218:219], v[20:21] op_sel:[0,1] op_sel_hi:[1,1] neg_lo:[0,1] neg_hi:[0,1]
  v_pk_add_f32 v[236:237], v[220:221], v[20:21] op_sel:[0,1] op_sel_hi:[1,1] neg_lo:[0,1] neg_hi:[0,1]
  v_pk_add_f32 v[238:239], v[222:223], v[20:21] op_sel:[0,1] op_sel_hi:[1,1] neg_lo:[0,1] neg_hi:[0,1]
  v_pk_add_f32 v[240:241], v[224:225], v[20:21] op_sel:[0,1] op_sel_hi:[1,1] neg_lo:[0,1] neg_hi:[0,1]
  v_fma_f32 v26, -v22, v24, 1.0
  v_fma_f32 v27, -v23, v25, 1.0
  v_pk_fma_f32 v[24:25], v[26:27], v[24:25], v[24:25]
  v_cvt_pk_bf16_f32 v226, v226, v227
  v_and_b32 v227, s12, v226
  v_lshlrev_b32 v226, 16, v226
  v_pk_mul_f32 v[226:227], v[226:227], v[24:25] op_sel_hi:[1,0]
  v_cvt_pk_bf16_f32 v48, v226, v227
  v_cvt_pk_bf16_f32 v228, v228, v229
  v_and_b32 v229, s12, v228
  v_lshlrev_b32 v228, 16, v228
  v_pk_mul_f32 v[228:229], v[228:229], v[24:25] op_sel_hi:[1,0]
  v_cvt_pk_bf16_f32 v49, v228, v229
  v_cvt_pk_bf16_f32 v230, v230, v231
  v_and_b32 v231, s12, v230
  v_lshlrev_b32 v230, 16, v230
  v_pk_mul_f32 v[230:231], v[230:231], v[24:25] op_sel_hi:[1,0]
  v_cvt_pk_bf16_f32 v50, v230, v231
  v_cvt_pk_bf16_f32 v232, v232, v233
  v_and_b32 v233, s12, v232
  v_lshlrev_b32 v232, 16, v232
  v_pk_mul_f32 v[232:233], v[232:233], v[24:25] op_sel_hi:[1,0]
  v_cvt_pk_bf16_f32 v51, v232, v233
  v_cvt_pk_bf16_f32 v234, v234, v235
  v_and_b32 v235, s12, v234
  v_lshlrev_b32 v234, 16, v234
  v_pk_mul_f32 v[234:235], v[234:235], v[24:25] op_sel:[0,1] op_sel_hi:[1,1]
  v_cvt_pk_bf16_f32 v52, v234, v235
  v_cvt_pk_bf16_f32 v236, v236, v237
  v_and_b32 v237, s12, v236
  v_lshlrev_b32 v236, 16, v236
  v_pk_mul_f32 v[236:237], v[236:237], v[24:25] op_sel:[0,1] op_sel_hi:[1,1]
  v_cvt_pk_bf16_f32 v53, v236, v237
  v_cvt_pk_bf16_f32 v238, v238, v239
  v_and_b32 v239, s12, v238
  v_lshlrev_b32 v238, 16, v238
  v_pk_mul_f32 v[238:239], v[238:239], v[24:25] op_sel:[0,1] op_sel_hi:[1,1]
  v_cvt_pk_bf16_f32 v54, v238, v239
  v_cvt_pk_bf16_f32 v240, v240, v241
  v_and_b32 v241, s12, v240
  v_lshlrev_b32 v240, 16, v240
  v_pk_mul_f32 v[240:241], v[240:241], v[24:25] op_sel:[0,1] op_sel_hi:[1,1]
  v_cvt_pk_bf16_f32 v55, v240, v241
  s_mov_b32 s6, 6291456
  s_cmp_lg_u32 s67, 0
  s_cbranch_scc1 L_fast_84
  buffer_store_dwordx4 v[48:51], v247, s[40:43], s6 offen offset:0 sc1
  buffer_store_dwordx4 v[52:55], v247, s[40:43], s6 offen offset:16 sc1
  s_branch L_sdone_85
L_fast_84:
  buffer_store_dwordx4 v[48:51], v247, s[40:43], s6 offen offset:0
  buffer_store_dwordx4 v[52:55], v247, s[40:43], s6 offen offset:16
L_sdone_85:
  s_add_u32 s76, s71, 0
  s_waitcnt vmcnt(0)
  s_cmp_lg_u32 s67, 0
  s_cbranch_scc1 L_fast_86
  buffer_store_dword v245, v246, s[40:43], s76 offen sc1
  s_branch L_sdone_87
L_fast_86:
  buffer_store_dword v245, v246, s[40:43], s76 offen
L_sdone_87:
  s_barrier
  s_cmp_ge_u32 s5, 7
  s_cselect_b32 s8, 7, 0
  s_sub_u32 s8, s5, s8
  s_mul_i32 s69, s8, 112
  s_mul_i32 s8, s3, 28
  s_add_u32 s69, s69, s8
  s_lshl_b32 s69, s69, 11
  s_add_u32 s69, s69, 35651584
  s_cmp_ge_u32 s5, 14
  s_cselect_b32 s69, 0x7ffffff0, s69
  s_cmp_eq_u32 s3, 0
  s_cbranch_scc1 L_nw0_88
  v_lshlrev_b32 v119, 4, v0
  s_add_u32 m0, s92, 73728
  s_add_u32 s93, s94, 73728
  buffer_load_dwordx4 v119, s[40:43], s93 offen lds
  s_add_u32 m0, s92, 76800
  s_add_u32 s93, s94, 76800
  buffer_load_dwordx4 v119, s[40:43], s93 offen lds
  s_add_u32 m0, s92, 79872
  s_add_u32 s93, s94, 79872
  buffer_load_dwordx4 v119, s[40:43], s93 offen lds
  s_add_u32 m0, s92, 82944
  s_add_u32 s93, s94, 82944
  buffer_load_dwordx4 v119, s[40:43], s93 offen lds
  s_add_u32 m0, s92, 86016
  s_add_u32 s93, s94, 86016
  buffer_load_dwordx4 v119, s[40:43], s93 offen lds
  s_add_u32 m0, s92, 89088
  s_add_u32 s93, s94, 89088
  buffer_load_dwordx4 v119, s[40:43], s93 offen lds
  s_add_u32 m0, s92, 92160
  s_add_u32 s93, s94, 92160
  buffer_load_dwordx4 v119, s[40:43], s93 offen lds
  s_add_u32 m0, s92, 95232
  s_add_u32 s93, s94, 95232
  buffer_load_dwordx4 v119, s[40:43], s93 offen lds
  s_cmp_eq_u32 s3, 3
  s_cbranch_scc1 L_w1x_89
  s_add_u32 m0, s92, 98304
  s_add_u32 s93, s94, 98304
  buffer_load_dwordx4 v119, s[40:43], s93 offen lds
L_w1x_89:
L_nw0_88:
  s_mov_b32 s95, 0
  v_and_b32 v242, 15, v0
  v_lshl_add_u32 v242, s3, 4, v242
  v_lshlrev_b32 v242, 2, v242
  s_add_u32 s76, s71, 0
  s_mov_b32 s77, 0
L_poll_90:
  buffer_load_dword v243, v242, s[40:43], s76 offen sc1
  s_add_u32 s77, s77, 1
  s_waitcnt vmcnt(0)
  v_cmp_ne_u32 vcc, s70, v243
  s_cmp_ge_u32 s77, 400000
  s_cbranch_scc1 L_pdone_91
  s_cbranch_vccnz L_poll_90
L_pdone_91:
  s_mov_b32 s65, 0
  s_mul_i32 s15, s95, 0
  s_add_u32 s15, s15, 16777216
  s_mul_i32 s11, s95, 0
  s_add_u32 s11, s11, 6291456
  s_lshl_b32 s6, s4, 7
  s_lshl_b32 s7, s3, 5
  s_add_u32 s6, s6, s7
  s_mul_i32 s6, s6, 896
  s_add_u32 s6, s6, s11
  s_add_u32 s7, s6, 14336
  v_lshlrev_b32 v3, 4, v0
  v_add_u32 v2, 0x1000, v3
  v_add_u32 v1, 0x2000, v3
  v_add_u32 v9, 0x3000, v3
  buffer_load_dwordx4 v[16:19], v3, s[40:43], s6 offen offset:0 sc1
  buffer_load_dwordx4 v[72:75], v3, s[40:43], s7 offen offset:0 sc1
  buffer_load_dwordx4 v[20:23], v3, s[40:43], s6 offen offset:1024 sc1
  buffer_load_dwordx4 v[76:79], v3, s[40:43], s7 offen offset:1024 sc1
  buffer_load_dwordx4 v[24:27], v3, s[40:43], s6 offen offset:2048 sc1
  buffer_load_dwordx4 v[80:83], v3, s[40:43], s7 offen offset:2048 sc1
  buffer_load_dwordx4 v[28:31], v3, s[40:43], s6 offen offset:3072 sc1
  buffer_load_dwordx4 v[84:87], v3, s[40:43], s7 offen offset:3072 sc1
  buffer_load_dwordx4 v[32:35], v2, s[40:43], s6 offen offset:0 sc1
  buffer_load_dwordx4 v[88:91], v2, s[40:43], s7 offen offset:0 sc1
  v_lshlrev_b32 v4, 4, v0
  v_add_u32 v5, 0x10000, v4
  v_add_u32 v6, 114688, v4
  s_lshl_b32 s88, s4, 2
  s_add_u32 s88, s88, s3
  s_mul_i32 s88, s88, 112
  s_mul_i32 s8, s5, 7
  s_add_u32 s88, s88, s8
  s_lshl_b32 s88, s88, 10
  s_add_u32 s88, s88, s15
  s_add_u32 s89, s88, 4096
  s_cmp_ge_u32 s5, 7
  s_cselect_b32 s8, 1, 0
  s_mul_i32 s9, s8, 7
  s_sub_u32 s9, s5, s9
  s_lshl_b32 s13, s4, 2
  s_lshl_b32 s8, s8, 1
  s_add_u32 s13, s13, s8
  s_mul_i32 s90, s13, 112
  s_mul_i32 s8, s3, 28
  s_add_u32 s90, s90, s8
  s_lshl_b32 s90, s90, 10
  s_add_u32 s90, s90, s15
  s_mul_i32 s91, s9, 112
  s_add_u32 s91, s91, s8
  s_lshl_b32 s91, s91, 11
  s_add_u32 s91, s91, 35651584
  s_mov_b32 s14, s9
  s_mov_b32 s76, 37810432
  v_mov_b32 v242, 0
  buffer_load_dword v243, v242, s[40:43], s76 offen sc1
  ds_read_b128 v[168:171], v4 offset:0
  ds_read_b128 v[172:175], v4 offset:14336
  ds_read_b128 v[176:179], v4 offset:28672
  ds_read_b128 v[180:183], v4 offset:43008
  ds_read_b128 v[184:187], v4 offset:1024
  ds_read_b128 v[188:191], v4 offset:15360
  ds_read_b128 v[192:195], v4 offset:29696
  ds_read_b128 v[196:199], v4 offset:44032
  ds_read_b128 v[226:229], v4 offset:2048
  ds_read_b128 v[230:233], v4 offset:16384
  ds_read_b128 v[234:237], v4 offset:30720
  ds_read_b128 v[238:241], v4 offset:45056
  buffer_load_dwordx4 v[36:39], v2, s[40:43], s6 offen offset:1024 sc1
  buffer_load_dwordx4 v[92:95], v2, s[40:43], s7 offen offset:1024 sc1
  s_waitcnt vmcnt(11)
  s_waitcnt lgkmcnt(8)
  v_mfma_f32_16x16x32_bf16 v[128:131], v[168:171], v[16:19], 0
  v_mfma_f32_16x16x32_bf16 v[132:135], v[168:171], v[72:75], 0
  v_mfma_f32_16x16x32_bf16 v[136:139], v[172:175], v[16:19], 0
  v_mfma_f32_16x16x32_bf16 v[140:143], v[172:175], v[72:75], 0
  v_mfma_f32_16x16x32_bf16 v[144:147], v[176:179], v[16:19], 0
  v_mfma_f32_16x16x32_bf16 v[148:151], v[176:179], v[72:75], 0
  v_mfma_f32_16x16x32_bf16 v[152:155], v[180:183], v[16:19], 0
  v_mfma_f32_16x16x32_bf16 v[156:159], v[180:183], v[72:75], 0
  ds_read_b128 v[168:171], v4 offset:3072
  ds_read_b128 v[172:175], v4 offset:17408
  ds_read_b128 v[176:179], v4 offset:31744
  ds_read_b128 v[180:183], v4 offset:46080
  buffer_load_dwordx4 v[40:43], v2, s[40:43], s6 offen offset:2048 sc1
  buffer_load_dwordx4 v[96:99], v2, s[40:43], s7 offen offset:2048 sc1
  s_waitcnt vmcnt(11)
  s_waitcnt lgkmcnt(8)
  v_mfma_f32_16x16x32_bf16 v[128:131], v[184:187], v[20:23], v[128:131]
  v_mfma_f32_16x16x32_bf16 v[132:135], v[184:187], v[76:79], v[132:135]
  v_mfma_f32_16x16x32_bf16 v[136:139], v[188:191], v[20:23], v[136:139]
  v_mfma_f32_16x16x32_bf16 v[140:143], v[188:191], v[76:79], v[140:143]
  v_mfma_f32_16x16x32_bf16 v[144:147], v[192:195], v[20:23], v[144:147]
  v_mfma_f32_16x16x32_bf16 v[148:151], v[192:195], v[76:79], v[148:151]
  v_mfma_f32_16x16x32_bf16 v[152:155], v[196:199], v[20:23], v[152:155]
  v_mfma_f32_16x16x32_bf16 v[156:159], v[196:199], v[76:79], v[156:159]
  ds_read_b128 v[184:187], v4 offset:4096
  ds_read_b128 v[188:191], v4 offset:18432
  ds_read_b128 v[192:195], v4 offset:32768
  ds_read_b128 v[196:199], v4 offset:47104
  buffer_load_dwordx4 v[44:47], v2, s[40:43], s6 offen offset:3072 sc1
  buffer_load_dwordx4 v[100:103], v2, s[40:43], s7 offen offset:3072 sc1
  s_waitcnt vmcnt(11)
  s_waitcnt lgkmcnt(8)
  v_mfma_f32_16x16x32_bf16 v[128:131], v[226:229], v[24:27], v[128:131]
  v_mfma_f32_16x16x32_bf16 v[132:135], v[226:229], v[80:83], v[132:135]
  v_mfma_f32_16x16x32_bf16 v[136:139], v[230:233], v[24:27], v[136:139]
  v_mfma_f32_16x16x32_bf16 v[140:143], v[230:233], v[80:83], v[140:143]
  v_mfma_f32_16x16x32_bf16 v[144:147], v[234:237], v[24:27], v[144:147]
  v_mfma_f32_16x16x32_bf16 v[148:151], v[234:237], v[80:83], v[148:151]
  v_mfma_f32_16x16x32_bf16 v[152:155], v[238:241], v[24:27], v[152:155]
  v_mfma_f32_16x16x32_bf16 v[156:159], v[238:241], v[80:83], v[156:159]
  ds_read_b128 v[226:229], v4 offset:5120
  ds_read_b128 v[230:233], v4 offset:19456
  ds_read_b128 v[234:237], v4 offset:33792
  ds_read_b128 v[238:241], v4 offset:48128
  buffer_load_dwordx4 v[48:51], v1, s[40:43], s6 offen offset:0 sc1
  buffer_load_dwordx4 v[104:107], v1, s[40:43], s7 offen offset:0 sc1
  s_waitcnt vmcnt(11)
  s_waitcnt lgkmcnt(8)
  v_mfma_f32_16x16x32_bf16 v[128:131], v[168:171], v[28:31], v[128:131]
  v_mfma_f32_16x16x32_bf16 v[132:135], v[168:171], v[84:87], v[132:135]
  v_mfma_f32_16x16x32_bf16 v[136:139], v[172:175], v[28:31], v[136:139]
  v_mfma_f32_16x16x32_bf16 v[140:143], v[172:175], v[84:87], v[140:143]
  v_mfma_f32_16x16x32_bf16 v[144:147], v[176:179], v[28:31], v[144:147]
  v_mfma_f32_16x16x32_bf16 v[148:151], v[176:179], v[84:87], v[148:151]
  v_mfma_f32_16x16x32_bf16 v[152:155], v[180:183], v[28:31], v[152:155]
  v_mfma_f32_16x16x32_bf16 v[156:159], v[180:183], v[84:87], v[156:159]
  s_waitcnt vmcnt(8)
  v_cmp_ne_u32 vcc, s70, v243
  s_cbranch_vccz L_ck_93
  s_mov_b32 s77, 0
L_poll_94:
  buffer_load_dword v243, v242, s[40:43], s76 offen sc1
  s_add_u32 s77, s77, 1
  s_waitcnt vmcnt(0)
  v_cmp_ne_u32 vcc, s70, v243
  s_cmp_ge_u32 s77, 400000
  s_cbranch_scc1 L_pdone_95
  s_cbranch_vccnz L_poll_94
L_pdone_95:
L_ck_93:
  s_add_u32 s9, s69, 0
  buffer_load_dwordx4 a[0:3], v4, s[40:43], s9 offen offset:0
  buffer_load_dwordx4 a[4:7], v4, s[40:43], s9 offen offset:1024
  ds_read_b128 v[168:171], v4 offset:6144
  ds_read_b128 v[172:175], v4 offset:20480
  ds_read_b128 v[176:179], v4 offset:34816
  ds_read_b128 v[180:183], v4 offset:49152
  buffer_load_dwordx4 v[52:55], v1, s[40:43], s6 offen offset:1024 sc1
  buffer_load_dwordx4 v[108:111], v1, s[40:43], s7 offen offset:1024 sc1
  s_waitcnt lgkmcnt(8)
  v_mfma_f32_16x16x32_bf16 v[128:131], v[184:187], v[32:35], v[128:131]
  v_mfma_f32_16x16x32_bf16 v[132:135], v[184:187], v[88:91], v[132:135]
  v_mfma_f32_16x16x32_bf16 v[136:139], v[188:191], v[32:35], v[136:139]
  v_mfma_f32_16x16x32_bf16 v[140:143], v[188:191], v[88:91], v[140:143]
  v_mfma_f32_16x16x32_bf16 v[144:147], v[192:195], v[32:35], v[144:147]
  v_mfma_f32_16x16x32_bf16 v[148:151], v[192:195], v[88:91], v[148:151]
  v_mfma_f32_16x16x32_bf16 v[152:155], v[196:199], v[32:35], v[152:155]
  v_mfma_f32_16x16x32_bf16 v[156:159], v[196:199], v[88:91], v[156:159]
  s_add_u32 s9, s69, 2048
  buffer_load_dwordx4 a[8:11], v4, s[40:43], s9 offen offset:0
  buffer_load_dwordx4 a[12:15], v4, s[40:43], s9 offen offset:1024
  ds_read_b128 v[184:187], v4 offset:7168
  ds_read_b128 v[188:191], v4 offset:21504
  ds_read_b128 v[192:195], v4 offset:35840
  ds_read_b128 v[196:199], v4 offset:50176
  buffer_load_dwordx4 v[56:59], v1, s[40:43], s6 offen offset:2048 sc1
  buffer_load_dwordx4 v[112:115], v1, s[40:43], s7 offen offset:2048 sc1
  s_waitcnt vmcnt(14)
  s_waitcnt lgkmcnt(8)
  v_mfma_f32_16x16x32_bf16 v[128:131], v[226:229], v[36:39], v[128:131]
  v_mfma_f32_16x16x32_bf16 v[132:135], v[226:229], v[92:95], v[132:135]
  v_mfma_f32_16x16x32_bf16 v[136:139], v[230:233], v[36:39], v[136:139]
  v_mfma_f32_16x16x32_bf16 v[140:143], v[230:233], v[92:95], v[140:143]
  v_mfma_f32_16x16x32_bf16 v[144:147], v[234:237], v[36:39], v[144:147]
  v_mfma_f32_16x16x32_bf16 v[148:151], v[234:237], v[92:95], v[148:151]
  v_mfma_f32_16x16x32_bf16 v[152:155], v[238:241], v[36:39], v[152:155]
  v_mfma_f32_16x16x32_bf16 v[156:159], v[238:241], v[92:95], v[156:159]
  s_add_u32 s9, s69, 4096
  buffer_load_dwordx4 a[16:19], v4, s[40:43], s9 offen offset:0
  buffer_load_dwordx4 a[20:23], v4, s[40:43], s9 offen offset:1024
  ds_read_b128 v[226:229], v4 offset:8192
  ds_read_b128 v[230:233], v4 offset:22528
  ds_read_b128 v[234:237], v4 offset:36864
  ds_read_b128 v[238:241], v4 offset:51200
  buffer_load_dwordx4 v[60:63], v1, s[40:43], s6 offen offset:3072 sc1
  buffer_load_dwordx4 v[116:119], v1, s[40:43], s7 offen offset:3072 sc1
  s_waitcnt vmcnt(16)
  s_waitcnt lgkmcnt(8)
  v_mfma_f32_16x16x32_bf16 v[128:131], v[168:171], v[40:43], v[128:131]
  v_mfma_f32_16x16x32_bf16 v[132:135], v[168:171], v[96:99], v[132:135]
  v_mfma_f32_16x16x32_bf16 v[136:139], v[172:175], v[40:43], v[136:139]
  v_mfma_f32_16x16x32_bf16 v[140:143], v[172:175], v[96:99], v[140:143]
  v_mfma_f32_16x16x32_bf16 v[144:147], v[176:179], v[40:43], v[144:147]
  v_mfma_f32_16x16x32_bf16 v[148:151], v[176:179], v[96:99], v[148:151]
  v_mfma_f32_16x16x32_bf16 v[152:155], v[180:183], v[40:43], v[152:155]
  v_mfma_f32_16x16x32_bf16 v[156:159], v[180:183], v[96:99], v[156:159]
  s_add_u32 s9, s69, 6144
  buffer_load_dwordx4 a[24:27], v4, s[40:43], s9 offen offset:0
  buffer_load_dwordx4 a[28:31], v4, s[40:43], s9 offen offset:1024
  ds_read_b128 v[168:171], v4 offset:9216
  ds_read_b128 v[172:175], v4 offset:23552
  ds_read_b128 v[176:179], v4 offset:37888
  ds_read_b128 v[180:183], v4 offset:52224
  buffer_load_dwordx4 v[64:67], v9, s[40:43], s6 offen offset:0 sc1
  buffer_load_dwordx4 v[120:123], v9, s[40:43], s7 offen offset:0 sc1
  s_waitcnt vmcnt(18)
  s_waitcnt lgkmcnt(8)
  v_mfma_f32_16x16x32_bf16 v[128:131], v[184:187], v[44:47], v[128:131]
  v_mfma_f32_16x16x32_bf16 v[132:135], v[184:187], v[100:103], v[132:135]
  v_mfma_f32_16x16x32_bf16 v[136:139], v[188:191], v[44:47], v[136:139]
  v_mfma_f32_16x16x32_bf16 v[140:143], v[188:191], v[100:103], v[140:143]
  v_mfma_f32_16x16x32_bf16 v[144:147], v[192:195], v[44:47], v[144:147]
  v_mfma_f32_16x16x32_bf16 v[148:151], v[192:195], v[100:103], v[148:151]
  v_mfma_f32_16x16x32_bf16 v[152:155], v[196:199], v[44:47], v[152:155]
  v_mfma_f32_16x16x32_bf16 v[156:159], v[196:199], v[100:103], v[156:159]
  s_add_u32 s9, s69, 14336
  buffer_load_dwordx4 a[56:59], v4, s[40:43], s9 offen offset:0
  buffer_load_dwordx4 a[60:63], v4, s[40:43], s9 offen offset:1024
  ds_read_b128 v[184:187], v4 offset:10240
  ds_read_b128 v[188:191], v4 offset:24576
  ds_read_b128 v[192:195], v4 offset:38912
  ds_read_b128 v[196:199], v4 offset:53248
  buffer_load_dwordx4 v[68:71], v9, s[40:43], s6 offen offset:1024 sc1
  buffer_load_dwordx4 v[124:127], v9, s[40:43], s7 offen offset:1024 sc1
  s_waitcnt vmcnt(20)
  s_waitcnt lgkmcnt(8)
  v_mfma_f32_16x16x32_bf16 v[128:131], v[226:229], v[48:51], v[128:131]
  v_mfma_f32_16x16x32_bf16 v[132:135], v[226:229], v[104:107], v[132:135]
  v_mfma_f32_16x16x32_bf16 v[136:139], v[230:233], v[48:51], v[136:139]
  v_mfma_f32_16x16x32_bf16 v[140:143], v[230:233], v[104:107], v[140:143]
  v_mfma_f32_16x16x32_bf16 v[144:147], v[234:237], v[48:51], v[144:147]
  v_mfma_f32_16x16x32_bf16 v[148:151], v[234:237], v[104:107], v[148:151]
  v_mfma_f32_16x16x32_bf16 v[152:155], v[238:241], v[48:51], v[152:155]
  v_mfma_f32_16x16x32_bf16 v[156:159], v[238:241], v[104:107], v[156:159]
  s_add_u32 s9, s69, 16384
  buffer_load_dwordx4 a[64:67], v4, s[40:43], s9 offen offset:0
  buffer_load_dwordx4 a[68:71], v4, s[40:43], s9 offen offset:1024
  ds_read_b128 v[226:229], v4 offset:11264
  ds_read_b128 v[230:233], v4 offset:25600
  ds_read_b128 v[234:237], v4 offset:39936
  ds_read_b128 v[238:241], v4 offset:54272
  s_waitcnt vmcnt(18)
  s_waitcnt lgkmcnt(8)
  v_mfma_f32_16x16x32_bf16 v[128:131], v[168:171], v[52:55], v[128:131]
  v_mfma_f32_16x16x32_bf16 v[132:135], v[168:171], v[108:111], v[132:135]
  v_mfma_f32_16x16x32_bf16 v[136:139], v[172:175], v[52:55], v[136:139]
  v_mfma_f32_16x16x32_bf16 v[140:143], v[172:175], v[108:111], v[140:143]
  v_mfma_f32_16x16x32_bf16 v[144:147], v[176:179], v[52:55], v[144:147]
  v_mfma_f32_16x16x32_bf16 v[148:151], v[176:179], v[108:111], v[148:151]
  v_mfma_f32_16x16x32_bf16 v[152:155], v[180:183], v[52:55], v[152:155]
  v_mfma_f32_16x16x32_bf16 v[156:159], v[180:183], v[108:111], v[156:159]
  s_add_u32 s9, s69, 18432
  buffer_load_dwordx4 a[72:75], v4, s[40:43], s9 offen offset:0
  buffer_load_dwordx4 a[76:79], v4, s[40:43], s9 offen offset:1024
  ds_read_b128 v[168:171], v4 offset:12288
  ds_read_b128 v[172:175], v4 offset:26624
  ds_read_b128 v[176:179], v4 offset:40960
  ds_read_b128 v[180:183], v4 offset:55296
  s_waitcnt vmcnt(16)
  s_waitcnt lgkmcnt(8)
  v_mfma_f32_16x16x32_bf16 v[128:131], v[184:187], v[56:59], v[128:131]
  v_mfma_f32_16x16x32_bf16 v[132:135], v[184:187], v[112:115], v[132:135]
  v_mfma_f32_16x16x32_bf16 v[136:139], v[188:191], v[56:59], v[136:139]
  v_mfma_f32_16x16x32_bf16 v[140:143], v[188:191], v[112:115], v[140:143]
  v_mfma_f32_16x16x32_bf16 v[144:147], v[192:195], v[56:59], v[144:147]
  v_mfma_f32_16x16x32_bf16 v[148:151], v[192:195], v[112:115], v[148:151]
  v_mfma_f32_16x16x32_bf16 v[152:155], v[196:199], v[56:59], v[152:155]
  v_mfma_f32_16x16x32_bf16 v[156:159], v[196:199], v[112:115], v[156:159]
  s_add_u32 s9, s69, 20480
  buffer_load_dwordx4 a[80:83], v4, s[40:43], s9 offen offset:0
  buffer_load_dwordx4 a[84:87], v4, s[40:43], s9 offen offset:1024
  ds_read_b128 v[184:187], v4 offset:13312
  ds_read_b128 v[188:191], v4 offset:27648
  ds_read_b128 v[192:195], v4 offset:41984
  ds_read_b128 v[196:199], v4 offset:56320
  s_waitcnt vmcnt(14)
  s_waitcnt lgkmcnt(8)
  v_mfma_f32_16x16x32_bf16 v[128:131], v[226:229], v[60:63], v[128:131]
  v_mfma_f32_16x16x32_bf16 v[132:135], v[226:229], v[116:119], v[132:135]
  v_mfma_f32_16x16x32_bf16 v[136:139], v[230:233], v[60:63], v[136:139]
  v_mfma_f32_16x16x32_bf16 v[140:143], v[230:233], v[116:119], v[140:143]
  v_mfma_f32_16x16x32_bf16 v[144:147], v[234:237], v[60:63], v[144:147]
  v_mfma_f32_16x16x32_bf16 v[148:151], v[234:237], v[116:119], v[148:151]
  v_mfma_f32_16x16x32_bf16 v[152:155], v[238:241], v[60:63], v[152:155]
  v_mfma_f32_16x16x32_bf16 v[156:159], v[238:241], v[116:119], v[156:159]
  s_add_u32 s9, s69, 28672
  buffer_load_dwordx4 a[112:115], v4, s[40:43], s9 offen offset:0
  buffer_load_dwordx4 a[116:119], v4, s[40:43], s9 offen offset:1024
  s_waitcnt vmcnt(12)
  s_waitcnt lgkmcnt(4)
  v_mfma_f32_16x16x32_bf16 v[128:131], v[168:171], v[64:67], v[128:131]
  v_mfma_f32_16x16x32_bf16 v[132:135], v[168:171], v[120:123], v[132:135]
  v_mfma_f32_16x16x32_bf16 v[136:139], v[172:175], v[64:67], v[136:139]
  v_mfma_f32_16x16x32_bf16 v[140:143], v[172:175], v[120:123], v[140:143]
  v_mfma_f32_16x16x32_bf16 v[144:147], v[176:179], v[64:67], v[144:147]
  v_mfma_f32_16x16x32_bf16 v[148:151], v[176:179], v[120:123], v[148:151]
  v_mfma_f32_16x16x32_bf16 v[152:155], v[180:183], v[64:67], v[152:155]
  v_mfma_f32_16x16x32_bf16 v[156:159], v[180:183], v[120:123], v[156:159]
  s_add_u32 s9, s69, 30720
  buffer_load_dwordx4 a[120:123], v4, s[40:43], s9 offen offset:0
  buffer_load_dwordx4 a[124:127], v4, s[40:43], s9 offen offset:1024
  s_waitcnt vmcnt(10)
  s_waitcnt lgkmcnt(0)
  v_mfma_f32_16x16x32_bf16 v[128:131], v[184:187], v[68:71], v[128:131]
  v_mfma_f32_16x16x32_bf16 v[132:135], v[184:187], v[124:127], v[132:135]
  v_mfma_f32_16x16x32_bf16 v[136:139], v[188:191], v[68:71], v[136:139]
  v_mfma_f32_16x16x32_bf16 v[140:143], v[188:191], v[124:127], v[140:143]
  v_mfma_f32_16x16x32_bf16 v[144:147], v[192:195], v[68:71], v[144:147]
  v_mfma_f32_16x16x32_bf16 v[148:151], v[192:195], v[124:127], v[148:151]
  v_mfma_f32_16x16x32_bf16 v[152:155], v[196:199], v[68:71], v[152:155]
  v_mfma_f32_16x16x32_bf16 v[156:159], v[196:199], v[124:127], v[156:159]
  s_add_u32 s9, s69, 32768
  buffer_load_dwordx4 a[128:131], v4, s[40:43], s9 offen offset:0
  buffer_load_dwordx4 a[132:135], v4, s[40:43], s9 offen offset:1024
  s_nop 7
  v_maximum3_f32 v128, v128, 0, 0
  v_maximum3_f32 v129, v129, 0, 0
  v_maximum3_f32 v130, v130, 0, 0
  v_maximum3_f32 v131, v131, 0, 0
  v_maximum3_f32 v132, v132, 0, 0
  v_maximum3_f32 v133, v133, 0, 0
  v_maximum3_f32 v134, v134, 0, 0
  v_maximum3_f32 v135, v135, 0, 0
  v_cvt_pk_bf16_f32 v128, v128, v129
  v_cvt_pk_bf16_f32 v129, v130, v131
  v_cvt_pk_bf16_f32 v130, v132, v133
  v_cvt_pk_bf16_f32 v131, v134, v135
  v_maximum3_f32 v136, v136, 0, 0
  v_maximum3_f32 v137, v137, 0, 0
  v_maximum3_f32 v138, v138, 0, 0
  v_maximum3_f32 v139, v139, 0, 0
  v_maximum3_f32 v140, v140, 0, 0
  v_maximum3_f32 v141, v141, 0, 0
  v_maximum3_f32 v142, v142, 0, 0
  v_maximum3_f32 v143, v143, 0, 0
  v_cvt_pk_bf16_f32 v136, v136, v137
  v_cvt_pk_bf16_f32 v137, v138, v139
  v_cvt_pk_bf16_f32 v138, v140, v141
  v_cvt_pk_bf16_f32 v139, v142, v143
  v_maximum3_f32 v144, v144, 0, 0
  v_maximum3_f32 v145, v145, 0, 0
  v_maximum3_f32 v146, v146, 0, 0
  v_maximum3_f32 v147, v147, 0, 0
  v_maximum3_f32 v148, v148, 0, 0
  v_maximum3_f32 v149, v149, 0, 0
  v_maximum3_f32 v150, v150, 0, 0
  v_maximum3_f32 v151, v151, 0, 0
  v_cvt_pk_bf16_f32 v144, v144, v145
  v_cvt_pk_bf16_f32 v145, v146, v147
  v_cvt_pk_bf16_f32 v146, v148, v149
  v_cvt_pk_bf16_f32 v147, v150, v151
  v_maximum3_f32 v152, v152, 0, 0
  v_maximum3_f32 v153, v153, 0, 0
  v_maximum3_f32 v154, v154, 0, 0
  v_maximum3_f32 v155, v155, 0, 0
  v_maximum3_f32 v156, v156, 0, 0
  v_maximum3_f32 v157, v157, 0, 0
  v_maximum3_f32 v158, v158, 0, 0
  v_maximum3_f32 v159, v159, 0, 0
  v_cvt_pk_bf16_f32 v152, v152, v153
  v_cvt_pk_bf16_f32 v153, v154, v155
  v_cvt_pk_bf16_f32 v154, v156, v157
  v_cvt_pk_bf16_f32 v155, v158, v159
  s_nop 1
  v_permlane16_swap_b32 v128, v130
  v_permlane16_swap_b32 v129, v131
  v_permlane16_swap_b32 v136, v138
  v_permlane16_swap_b32 v137, v139
  v_permlane16_swap_b32 v144, v146
  v_permlane16_swap_b32 v145, v147
  v_permlane16_swap_b32 v152, v154
  v_permlane16_swap_b32 v153, v155
  s_cmp_lg_u32 s65, 0
  s_cbranch_scc1 L_fast_96
  buffer_store_dwordx4 v[128:131], v4, s[40:43], s88 offen offset:0 sc1
  buffer_store_dwordx4 v[136:139], v4, s[40:43], s88 offen offset:1024 sc1
  buffer_store_dwordx4 v[144:147], v4, s[40:43], s88 offen offset:2048 sc1
  buffer_store_dwordx4 v[152:155], v4, s[40:43], s88 offen offset:3072 sc1
  s_branch L_sdone_97
L_fast_96:
  buffer_store_dwordx4 v[128:131], v4, s[40:43], s88 offen offset:0
  buffer_store_dwordx4 v[136:139], v4, s[40:43], s88 offen offset:1024
  buffer_store_dwordx4 v[144:147], v4, s[40:43], s88 offen offset:2048
  buffer_store_dwordx4 v[152:155], v4, s[40:43], s88 offen offset:3072
L_sdone_97:
  s_barrier
  ds_read_b128 v[168:171], v4 offset:57344
  ds_read_b128 v[172:175], v5 offset:6144
  ds_read_b128 v[176:179], v5 offset:20480
  ds_read_b128 v[184:187], v4 offset:58368
  ds_read_b128 v[188:191], v5 offset:7168
  ds_read_b128 v[192:195], v5 offset:21504
  ds_read_b128 v[226:229], v4 offset:59392
  ds_read_b128 v[230:233], v5 offset:8192
  ds_read_b128 v[234:237], v5 offset:22528
  s_waitcnt lgkmcnt(6)
  v_mfma_f32_16x16x32_bf16 v[128:131], v[168:171], v[16:19], 0
  v_mfma_f32_16x16x32_bf16 v[132:135], v[168:171], v[72:75], 0
  v_mfma_f32_16x16x32_bf16 v[136:139], v[172:175], v[16:19], 0
  v_mfma_f32_16x16x32_bf16 v[140:143], v[172:175], v[72:75], 0
  v_mfma_f32_16x16x32_bf16 v[144:147], v[176:179], v[16:19], 0
  v_mfma_f32_16x16x32_bf16 v[148:151], v[176:179], v[72:75], 0
  ds_read_b128 v[168:171], v4 offset:60416
  ds_read_b128 v[172:175], v5 offset:9216
  ds_read_b128 v[176:179], v5 offset:23552
  s_waitcnt lgkmcnt(6)
  v_mfma_f32_16x16x32_bf16 v[128:131], v[184:187], v[20:23], v[128:131]
  v_mfma_f32_16x16x32_bf16 v[132:135], v[184:187], v[76:79], v[132:135]
  v_mfma_f32_16x16x32_bf16 v[136:139], v[188:191], v[20:23], v[136:139]
  v_mfma_f32_16x16x32_bf16 v[140:143], v[188:191], v[76:79], v[140:143]
  v_mfma_f32_16x16x32_bf16 v[144:147], v[192:195], v[20:23], v[144:147]
  v_mfma_f32_16x16x32_bf16 v[148:151], v[192:195], v[76:79], v[148:151]
  ds_read_b128 v[184:187], v4 offset:61440
  ds_read_b128 v[188:191], v5 offset:10240
  ds_read_b128 v[192:195], v5 offset:24576
  s_waitcnt vmcnt(0)
  s_add_u32 s76, s71, 4096
  s_cmp_lg_u32 s67, 0
  s_cbranch_scc1 L_fast_98
  buffer_store_dword v245, v246, s[40:43], s76 offen sc1
  s_branch L_sdone_99
L_fast_98:
  buffer_store_dword v245, v246, s[40:43], s76 offen
L_sdone_99:
  s_cmp_ge_u32 s5, 7
  s_cselect_b32 s77, 2, 0
  v_bfe_u32 v242, v0, 1, 2
  v_lshl_add_u32 v242, s3, 2, v242
  v_lshl_add_u32 v242, v242, 2, s77
  v_and_b32 v243, 1, v0
  v_add_u32 v242, v242, v243
  v_lshlrev_b32 v242, 2, v242
  s_waitcnt lgkmcnt(6)
  v_mfma_f32_16x16x32_bf16 v[128:131], v[226:229], v[24:27], v[128:131]
  v_mfma_f32_16x16x32_bf16 v[132:135], v[226:229], v[80:83], v[132:135]
  v_mfma_f32_16x16x32_bf16 v[136:139], v[230:233], v[24:27], v[136:139]
  v_mfma_f32_16x16x32_bf16 v[140:143], v[230:233], v[80:83], v[140:143]
  v_mfma_f32_16x16x32_bf16 v[144:147], v[234:237], v[24:27], v[144:147]
  v_mfma_f32_16x16x32_bf16 v[148:151], v[234:237], v[80:83], v[148:151]
  s_add_u32 s9, s69, 34816
  buffer_load_dwordx4 a[136:139], v4, s[40:43], s9 offen offset:0
  buffer_load_dwordx4 a[140:143], v4, s[40:43], s9 offen offset:1024
  s_add_u32 s9, s69, 43008
  buffer_load_dwordx4 a[168:171], v4, s[40:43], s9 offen offset:0
  buffer_load_dwordx4 a[172:175], v4, s[40:43], s9 offen offset:1024
  ds_read_b128 v[226:229], v4 offset:62464
  ds_read_b128 v[230:233], v5 offset:11264
  ds_read_b128 v[234:237], v5 offset:25600
  s_waitcnt lgkmcnt(6)
  v_mfma_f32_16x16x32_bf16 v[128:131], v[168:171], v[28:31], v[128:131]
  v_mfma_f32_16x16x32_bf16 v[132:135], v[168:171], v[84:87], v[132:135]
  v_mfma_f32_16x16x32_bf16 v[136:139], v[172:175], v[28:31], v[136:139]
  v_mfma_f32_16x16x32_bf16 v[140:143], v[172:175], v[84:87], v[140:143]
  v_mfma_f32_16x16x32_bf16 v[144:147], v[176:179], v[28:31], v[144:147]
  v_mfma_f32_16x16x32_bf16 v[148:151], v[176:179], v[84:87], v[148:151]
  s_add_u32 s9, s69, 45056
  buffer_load_dwordx4 a[176:179], v4, s[40:43], s9 offen offset:0
  buffer_load_dwordx4 a[180:183], v4, s[40:43], s9 offen offset:1024
  s_add_u32 s9, s69, 47104
  buffer_load_dwordx4 a[184:187], v4, s[40:43], s9 offen offset:0
  buffer_load_dwordx4 a[188:191], v4, s[40:43], s9 offen offset:1024
  ds_read_b128 v[168:171], v4 offset:63488
  ds_read_b128 v[172:175], v5 offset:12288
  ds_read_b128 v[176:179], v5 offset:26624
  s_waitcnt lgkmcnt(6)
  v_mfma_f32_16x16x32_bf16 v[128:131], v[184:187], v[32:35], v[128:131]
  v_mfma_f32_16x16x32_bf16 v[132:135], v[184:187], v[88:91], v[132:135]
  v_mfma_f32_16x16x32_bf16 v[136:139], v[188:191], v[32:35], v[136:139]
  v_mfma_f32_16x16x32_bf16 v[140:143], v[188:191], v[88:91], v[140:143]
  v_mfma_f32_16x16x32_bf16 v[144:147], v[192:195], v[32:35], v[144:147]
  v_mfma_f32_16x16x32_bf16 v[148:151], v[192:195], v[88:91], v[148:151]
  s_add_u32 s9, s69, 49152
  buffer_load_dwordx4 a[192:195], v4, s[40:43], s9 offen offset:0
  buffer_load_dwordx4 a[196:199], v4, s[40:43], s9 offen offset:1024
  s_add_u32 s9, s69, 8192
  buffer_load_dwordx4 a[32:35], v4, s[40:43], s9 offen offset:0
  buffer_load_dwordx4 a[36:39], v4, s[40:43], s9 offen offset:1024
  ds_read_b128 v[184:187], v4 offset:64512
  ds_read_b128 v[188:191], v5 offset:13312
  ds_read_b128 v[192:195], v5 offset:27648
  s_waitcnt lgkmcnt(6)
  v_mfma_f32_16x16x32_bf16 v[128:131], v[226:229], v[36:39], v[128:131]
  v_mfma_f32_16x16x32_bf16 v[132:135], v[226:229], v[92:95], v[132:135]
  v_mfma_f32_16x16x32_bf16 v[136:139], v[230:233], v[36:39], v[136:139]
  v_mfma_f32_16x16x32_bf16 v[140:143], v[230:233], v[92:95], v[140:143]
  v_mfma_f32_16x16x32_bf16 v[144:147], v[234:237], v[36:39], v[144:147]
  v_mfma_f32_16x16x32_bf16 v[148:151], v[234:237], v[92:95], v[148:151]
  ds_read_b128 v[226:229], v5 offset:0
  ds_read_b128 v[230:233], v5 offset:14336
  ds_read_b128 v[234:237], v5 offset:28672
  buffer_load_dword v243, v242, s[40:43], s76 offen sc1
  s_waitcnt lgkmcnt(6)
  v_mfma_f32_16x16x32_bf16 v[128:131], v[168:171], v[40:43], v[128:131]
  v_mfma_f32_16x16x32_bf16 v[132:135], v[168:171], v[96:99], v[132:135]
  v_mfma_f32_16x16x32_bf16 v[136:139], v[172:175], v[40:43], v[136:139]
  v_mfma_f32_16x16x32_bf16 v[140:143], v[172:175], v[96:99], v[140:143]
  v_mfma_f32_16x16x32_bf16 v[144:147], v[176:179], v[40:43], v[144:147]
  v_mfma_f32_16x16x32_bf16 v[148:151], v[176:179], v[96:99], v[148:151]
  s_add_u32 s9, s69, 10240
  buffer_load_dwordx4 a[40:43], v4, s[40:43], s9 offen offset:0
  buffer_load_dwordx4 a[44:47], v4, s[40:43], s9 offen offset:1024
  s_add_u32 s9, s69, 12288
  buffer_load_dwordx4 a[48:51], v4, s[40:43], s9 offen offset:0
  buffer_load_dwordx4 a[52:55], v4, s[40:43], s9 offen offset:1024
  ds_read_b128 v[168:171], v5 offset:1024
  ds_read_b128 v[172:175], v5 offset:15360
  ds_read_b128 v[176:179], v5 offset:29696
  s_waitcnt lgkmcnt(6)
  v_mfma_f32_16x16x32_bf16 v[128:131], v[184:187], v[44:47], v[128:131]
  v_mfma_f32_16x16x32_bf16 v[132:135], v[184:187], v[100:103], v[132:135]
  v_mfma_f32_16x16x32_bf16 v[136:139], v[188:191], v[44:47], v[136:139]
  v_mfma_f32_16x16x32_bf16 v[140:143], v[188:191], v[100:103], v[140:143]
  v_mfma_f32_16x16x32_bf16 v[144:147], v[192:195], v[44:47], v[144:147]
  v_mfma_f32_16x16x32_bf16 v[148:151], v[192:195], v[100:103], v[148:151]
  s_add_u32 s9, s69, 22528
  buffer_load_dwordx4 a[88:91], v4, s[40:43], s9 offen offset:0
  buffer_load_dwordx4 a[92:95], v4, s[40:43], s9 offen offset:1024
  s_add_u32 s9, s69, 24576
  buffer_load_dwordx4 a[96:99], v4, s[40:43], s9 offen offset:0
  buffer_load_dwordx4 a[100:103], v4, s[40:43], s9 offen offset:1024
  ds_read_b128 v[184:187], v5 offset:2048
  ds_read_b128 v[188:191], v5 offset:16384
  ds_read_b128 v[192:195], v5 offset:30720
  s_waitcnt lgkmcnt(6)
  v_mfma_f32_16x16x32_bf16 v[128:131], v[226:229], v[48:51], v[128:131]
  v_mfma_f32_16x16x32_bf16 v[132:135], v[226:229], v[104:107], v[132:135]
  v_mfma_f32_16x16x32_bf16 v[136:139], v[230:233], v[48:51], v[136:139]
  v_mfma_f32_16x16x32_bf16 v[140:143], v[230:233], v[104:107], v[140:143]
  v_mfma_f32_16x16x32_bf16 v[144:147], v[234:237], v[48:51], v[144:147]
  v_mfma_f32_16x16x32_bf16 v[148:151], v[234:237], v[104:107], v[148:151]
  s_add_u32 s9, s69, 26624
  buffer_load_dwordx4 a[104:107], v4, s[40:43], s9 offen offset:0
  buffer_load_dwordx4 a[108:111], v4, s[40:43], s9 offen offset:1024
  s_add_u32 s9, s69, 36864
  buffer_load_dwordx4 a[144:147], v4, s[40:43], s9 offen offset:0
  buffer_load_dwordx4 a[148:151], v4, s[40:43], s9 offen offset:1024
  ds_read_b128 v[226:229], v5 offset:3072
  ds_read_b128 v[230:233], v5 offset:17408
  ds_read_b128 v[234:237], v5 offset:31744
  s_waitcnt lgkmcnt(6)
  v_mfma_f32_16x16x32_bf16 v[128:131], v[168:171], v[52:55], v[128:131]
  v_mfma_f32_16x16x32_bf16 v[132:135], v[168:171], v[108:111], v[132:135]
  v_mfma_f32_16x16x32_bf16 v[136:139], v[172:175], v[52:55], v[136:139]
  v_mfma_f32_16x16x32_bf16 v[140:143], v[172:175], v[108:111], v[140:143]
  v_mfma_f32_16x16x32_bf16 v[144:147], v[176:179], v[52:55], v[144:147]
  v_mfma_f32_16x16x32_bf16 v[148:151], v[176:179], v[108:111], v[148:151]
  s_add_u32 s9, s69, 38912
  buffer_load_dwordx4 a[152:155], v4, s[40:43], s9 offen offset:0
  buffer_load_dwordx4 a[156:159], v4, s[40:43], s9 offen offset:1024
  s_add_u32 s9, s69, 40960
  buffer_load_dwordx4 a[160:163], v4, s[40:43], s9 offen offset:0
  buffer_load_dwordx4 a[164:167], v4, s[40:43], s9 offen offset:1024
  ds_read_b128 v[168:171], v5 offset:4096
  ds_read_b128 v[172:175], v5 offset:18432
  ds_read_b128 v[176:179], v5 offset:32768
  s_cmp_ge_u32 s5, 14
  s_cbranch_scc1 L_pc_100
  s_waitcnt vmcnt(16)
  v_cmp_ne_u32 vcc, s70, v243
  s_cbranch_vccz L_ck_101
  s_mov_b32 s77, 0
L_poll_102:
  buffer_load_dword v243, v242, s[40:43], s76 offen sc1
  s_add_u32 s77, s77, 1
  s_waitcnt vmcnt(0)
  v_cmp_ne_u32 vcc, s70, v243
  s_cmp_ge_u32 s77, 400000
  s_cbranch_scc1 L_pdone_103
  s_cbranch_vccnz L_poll_102
L_pdone_103:
L_ck_101:
L_pc_100:
  s_waitcnt lgkmcnt(6)
  v_mfma_f32_16x16x32_bf16 v[128:131], v[184:187], v[56:59], v[128:131]
  v_mfma_f32_16x16x32_bf16 v[132:135], v[184:187], v[112:115], v[132:135]
  v_mfma_f32_16x16x32_bf16 v[136:139], v[188:191], v[56:59], v[136:139]
  v_mfma_f32_16x16x32_bf16 v[140:143], v[188:191], v[112:115], v[140:143]
  v_mfma_f32_16x16x32_bf16 v[144:147], v[192:195], v[56:59], v[144:147]
  v_mfma_f32_16x16x32_bf16 v[148:151], v[192:195], v[112:115], v[148:151]
  s_cmp_ge_u32 s5, 14
  s_cbranch_scc1 L_pc_104
  s_add_u32 s8, s90, 0
  buffer_load_dwordx4 v[16:19], v4, s[40:43], s8 offen sc1
  buffer_load_dwordx4 v[72:75], v6, s[40:43], s8 offen sc1
L_pc_104:
  ds_read_b128 v[184:187], v5 offset:5120
  ds_read_b128 v[188:191], v5 offset:19456
  ds_read_b128 v[192:195], v5 offset:33792
  s_waitcnt lgkmcnt(6)
  v_mfma_f32_16x16x32_bf16 v[128:131], v[226:229], v[60:63], v[128:131]
  v_mfma_f32_16x16x32_bf16 v[132:135], v[226:229], v[116:119], v[132:135]
  v_mfma_f32_16x16x32_bf16 v[136:139], v[230:233], v[60:63], v[136:139]
  v_mfma_f32_16x16x32_bf16 v[140:143], v[230:233], v[116:119], v[140:143]
  v_mfma_f32_16x16x32_bf16 v[144:147], v[234:237], v[60:63], v[144:147]
  v_mfma_f32_16x16x32_bf16 v[148:151], v[234:237], v[116:119], v[148:151]
  s_cmp_ge_u32 s5, 14
  s_cbranch_scc1 L_pc_105
  s_add_u32 s8, s90, 1024
  buffer_load_dwordx4 v[20:23], v4, s[40:43], s8 offen sc1
  buffer_load_dwordx4 v[76:79], v6, s[40:43], s8 offen sc1
L_pc_105:
  s_waitcnt lgkmcnt(3)
  v_mfma_f32_16x16x32_bf16 v[128:131], v[168:171], v[64:67], v[128:131]
  v_mfma_f32_16x16x32_bf16 v[132:135], v[168:171], v[120:123], v[132:135]
  v_mfma_f32_16x16x32_bf16 v[136:139], v[172:175], v[64:67], v[136:139]
  v_mfma_f32_16x16x32_bf16 v[140:143], v[172:175], v[120:123], v[140:143]
  v_mfma_f32_16x16x32_bf16 v[144:147], v[176:179], v[64:67], v[144:147]
  v_mfma_f32_16x16x32_bf16 v[148:151], v[176:179], v[120:123], v[148:151]
  s_cmp_ge_u32 s5, 14
  s_cbranch_scc1 L_pc_106
  s_add_u32 s8, s90, 2048
  buffer_load_dwordx4 v[24:27], v4, s[40:43], s8 offen sc1
  buffer_load_dwordx4 v[80:83], v6, s[40:43], s8 offen sc1
L_pc_106:
  s_waitcnt lgkmcnt(0)
  v_mfma_f32_16x16x32_bf16 v[128:131], v[184:187], v[68:71], v[128:131]
  v_mfma_f32_16x16x32_bf16 v[132:135], v[184:187], v[124:127], v[132:135]
  v_mfma_f32_16x16x32_bf16 v[136:139], v[188:191], v[68:71], v[136:139]
  v_mfma_f32_16x16x32_bf16 v[140:143], v[188:191], v[124:127], v[140:143]
  v_mfma_f32_16x16x32_bf16 v[144:147], v[192:195], v[68:71], v[144:147]
  v_mfma_f32_16x16x32_bf16 v[148:151], v[192:195], v[124:127], v[148:151]
  s_nop 7
  v_maximum3_f32 v128, v128, 0, 0
  v_maximum3_f32 v129, v129, 0, 0
  v_maximum3_f32 v130, v130, 0, 0
  v_maximum3_f32 v131, v131, 0, 0
  v_maximum3_f32 v132, v132, 0, 0
  v_maximum3_f32 v133, v133, 0, 0
  v_maximum3_f32 v134, v134, 0, 0
  v_maximum3_f32 v135, v135, 0, 0
  v_cvt_pk_bf16_f32 v128, v128, v129
  v_cvt_pk_bf16_f32 v129, v130, v131
  v_cvt_pk_bf16_f32 v130, v132, v133
  v_cvt_pk_bf16_f32 v131, v134, v135
  v_maximum3_f32 v136, v136, 0, 0
  v_maximum3_f32 v137, v137, 0, 0
  v_maximum3_f32 v138, v138, 0, 0
  v_maximum3_f32 v139, v139, 0, 0
  v_maximum3_f32 v140, v140, 0, 0
  v_maximum3_f32 v141, v141, 0, 0
  v_maximum3_f32 v142, v142, 0, 0
  v_maximum3_f32 v143, v143, 0, 0
  v_cvt_pk_bf16_f32 v136, v136, v137
  v_cvt_pk_bf16_f32 v137, v138, v139
  v_cvt_pk_bf16_f32 v138, v140, v141
  v_cvt_pk_bf16_f32 v139, v142, v143
  v_maximum3_f32 v144, v144, 0, 0
  v_maximum3_f32 v145, v145, 0, 0
  v_maximum3_f32 v146, v146, 0, 0
  v_maximum3_f32 v147, v147, 0, 0
  v_maximum3_f32 v148, v148, 0, 0
  v_maximum3_f32 v149, v149, 0, 0
  v_maximum3_f32 v150, v150, 0, 0
  v_maximum3_f32 v151, v151, 0, 0
  v_cvt_pk_bf16_f32 v144, v144, v145
  v_cvt_pk_bf16_f32 v145, v146, v147
  v_cvt_pk_bf16_f32 v146, v148, v149
  v_cvt_pk_bf16_f32 v147, v150, v151
  s_nop 1
  v_permlane16_swap_b32 v128, v130
  v_permlane16_swap_b32 v129, v131
  v_permlane16_swap_b32 v136, v138
  v_permlane16_swap_b32 v137, v139
  v_permlane16_swap_b32 v144, v146
  v_permlane16_swap_b32 v145, v147
  s_cmp_lg_u32 s65, 0
  s_cbranch_scc1 L_fast_107
  buffer_store_dwordx4 v[128:131], v4, s[40:43], s89 offen offset:0 sc1
  buffer_store_dwordx4 v[136:139], v4, s[40:43], s89 offen offset:1024 sc1
  buffer_store_dwordx4 v[144:147], v4, s[40:43], s89 offen offset:2048 sc1
  s_branch L_sdone_108
L_fast_107:
  buffer_store_dwordx4 v[128:131], v4, s[40:43], s89 offen offset:0
  buffer_store_dwordx4 v[136:139], v4, s[40:43], s89 offen offset:1024
  buffer_store_dwordx4 v[144:147], v4, s[40:43], s89 offen offset:2048
L_sdone_108:
  s_cmp_lt_u32 s5, 14
  s_cbranch_scc1 L_g2_109
  s_add_u32 s76, s71, 8192
  s_waitcnt vmcnt(0)
  s_cmp_lg_u32 s67, 0
  s_cbranch_scc1 L_fast_110
  buffer_store_dword v245, v246, s[40:43], s76 offen sc1
  s_branch L_sdone_111
L_fast_110:
  buffer_store_dword v245, v246, s[40:43], s76 offen
L_sdone_111:
  s_branch L_nog2_92
L_g2_109:
  s_add_u32 s8, s90, 3072
  buffer_load_dwordx4 v[28:31], v4, s[40:43], s8 offen sc1
  buffer_load_dwordx4 v[84:87], v6, s[40:43], s8 offen sc1
  s_add_u32 s8, s90, 7168
  buffer_load_dwordx4 v[32:35], v4, s[40:43], s8 offen sc1
  buffer_load_dwordx4 v[88:91], v6, s[40:43], s8 offen sc1
  s_add_u32 s8, s90, 8192
  buffer_load_dwordx4 v[36:39], v4, s[40:43], s8 offen sc1
  buffer_load_dwordx4 v[92:95], v6, s[40:43], s8 offen sc1
  s_waitcnt vmcnt(6)
  s_add_u32 s76, s71, 8192
  s_cmp_lg_u32 s67, 0
  s_cbranch_scc1 L_fast_112
  buffer_store_dword v245, v246, s[40:43], s76 offen sc1
  s_branch L_sdone_113
L_fast_112:
  buffer_store_dword v245, v246, s[40:43], s76 offen
L_sdone_113:
  s_add_u32 s8, s90, 9216
  buffer_load_dwordx4 v[40:43], v4, s[40:43], s8 offen sc1
  buffer_load_dwordx4 v[96:99], v6, s[40:43], s8 offen sc1
  v_mfma_f32_32x32x16_bf16 v[128:143], a[0:3], v[16:19], 0
  v_mfma_f32_32x32x16_bf16 v[144:159], a[0:3], v[72:75], 0
  v_mfma_f32_32x32x16_bf16 v[160:175], a[4:7], v[16:19], 0
  v_mfma_f32_32x32x16_bf16 v[176:191], a[4:7], v[72:75], 0
  s_add_u32 s8, s90, 10240
  buffer_load_dwordx4 v[44:47], v4, s[40:43], s8 offen sc1
  buffer_load_dwordx4 v[100:103], v6, s[40:43], s8 offen sc1
  v_mfma_f32_32x32x16_bf16 v[128:143], a[8:11], v[20:23], v[128:143]
  v_mfma_f32_32x32x16_bf16 v[144:159], a[8:11], v[76:79], v[144:159]
  v_mfma_f32_32x32x16_bf16 v[160:175], a[12:15], v[20:23], v[160:175]
  v_mfma_f32_32x32x16_bf16 v[176:191], a[12:15], v[76:79], v[176:191]
  s_add_u32 s8, s90, 14336
  buffer_load_dwordx4 v[48:51], v4, s[40:43], s8 offen sc1
  buffer_load_dwordx4 v[104:107], v6, s[40:43], s8 offen sc1
  v_mfma_f32_32x32x16_bf16 v[128:143], a[16:19], v[24:27], v[128:143]
  v_mfma_f32_32x32x16_bf16 v[144:159], a[16:19], v[80:83], v[144:159]
  v_mfma_f32_32x32x16_bf16 v[160:175], a[20:23], v[24:27], v[160:175]
  v_mfma_f32_32x32x16_bf16 v[176:191], a[20:23], v[80:83], v[176:191]
  s_add_u32 s8, s90, 15360
  buffer_load_dwordx4 v[52:55], v4, s[40:43], s8 offen sc1
  buffer_load_dwordx4 v[108:111], v6, s[40:43], s8 offen sc1
  s_waitcnt vmcnt(13)
  v_mfma_f32_32x32x16_bf16 v[128:143], a[24:27], v[28:31], v[128:143]
  v_mfma_f32_32x32x16_bf16 v[144:159], a[24:27], v[84:87], v[144:159]
  v_mfma_f32_32x32x16_bf16 v[160:175], a[28:31], v[28:31], v[160:175]
  v_mfma_f32_32x32x16_bf16 v[176:191], a[28:31], v[84:87], v[176:191]
  s_add_u32 s8, s90, 16384
  buffer_load_dwordx4 v[56:59], v4, s[40:43], s8 offen sc1
  buffer_load_dwordx4 v[112:115], v6, s[40:43], s8 offen sc1
  s_waitcnt vmcnt(13)
  v_mfma_f32_32x32x16_bf16 v[128:143], a[56:59], v[32:35], v[128:143]
  v_mfma_f32_32x32x16_bf16 v[144:159], a[56:59], v[88:91], v[144:159]
  v_mfma_f32_32x32x16_bf16 v[160:175], a[60:63], v[32:35], v[160:175]
  v_mfma_f32_32x32x16_bf16 v[176:191], a[60:63], v[88:91], v[176:191]
  s_add_u32 s8, s90, 17408
  buffer_load_dwordx4 v[60:63], v4, s[40:43], s8 offen sc1
  buffer_load_dwordx4 v[116:119], v6, s[40:43], s8 offen sc1
  s_waitcnt vmcnt(13)
  v_mfma_f32_32x32x16_bf16 v[128:143], a[64:67], v[36:39], v[128:143]
  v_mfma_f32_32x32x16_bf16 v[144:159], a[64:67], v[92:95], v[144:159]
  v_mfma_f32_32x32x16_bf16 v[160:175], a[68:71], v[36:39], v[160:175]
  v_mfma_f32_32x32x16_bf16 v[176:191], a[68:71], v[92:95], v[176:191]
  buffer_load_dword v243, v242, s[40:43], s76 offen sc1
  s_add_u32 s8, s90, 21504
  buffer_load_dwordx4 v[64:67], v4, s[40:43], s8 offen sc1
  buffer_load_dwordx4 v[120:123], v6, s[40:43], s8 offen sc1
  s_waitcnt vmcnt(13)
  v_mfma_f32_32x32x16_bf16 v[128:143], a[72:75], v[40:43], v[128:143]
  v_mfma_f32_32x32x16_bf16 v[144:159], a[72:75], v[96:99], v[144:159]
  v_mfma_f32_32x32x16_bf16 v[160:175], a[76:79], v[40:43], v[160:175]
  v_mfma_f32_32x32x16_bf16 v[176:191], a[76:79], v[96:99], v[176:191]
  s_add_u32 s8, s90, 22528
  buffer_load_dwordx4 v[68:71], v4, s[40:43], s8 offen sc1
  buffer_load_dwordx4 v[124:127], v6, s[40:43], s8 offen sc1
  s_waitcnt vmcnt(13)
  v_mfma_f32_32x32x16_bf16 v[128:143], a[80:83], v[44:47], v[128:143]
  v_mfma_f32_32x32x16_bf16 v[144:159], a[80:83], v[100:103], v[144:159]
  v_mfma_f32_32x32x16_bf16 v[160:175], a[84:87], v[44:47], v[160:175]
  v_mfma_f32_32x32x16_bf16 v[176:191], a[84:87], v[100:103], v[176:191]
  s_add_u32 s8, s90, 23552
  buffer_load_dwordx4 v[16:19], v4, s[40:43], s8 offen sc1
  buffer_load_dwordx4 v[72:75], v6, s[40:43], s8 offen sc1
  s_waitcnt vmcnt(13)
  v_mfma_f32_32x32x16_bf16 v[128:143], a[112:115], v[48:51], v[128:143]
  v_mfma_f32_32x32x16_bf16 v[144:159], a[112:115], v[104:107], v[144:159]
  v_mfma_f32_32x32x16_bf16 v[160:175], a[116:119], v[48:51], v[160:175]
  v_mfma_f32_32x32x16_bf16 v[176:191], a[116:119], v[104:107], v[176:191]
  s_add_u32 s8, s90, 24576
  buffer_load_dwordx4 v[20:23], v4, s[40:43], s8 offen sc1
  buffer_load_dwordx4 v[76:79], v6, s[40:43], s8 offen sc1
  s_waitcnt vmcnt(13)
  v_mfma_f32_32x32x16_bf16 v[128:143], a[120:123], v[52:55], v[128:143]
  v_mfma_f32_32x32x16_bf16 v[144:159], a[120:123], v[108:111], v[144:159]
  v_mfma_f32_32x32x16_bf16 v[160:175], a[124:127], v[52:55], v[160:175]
  v_mfma_f32_32x32x16_bf16 v[176:191], a[124:127], v[108:111], v[176:191]
  s_waitcnt vmcnt(8)
  v_cmp_ne_u32 vcc, s70, v243
  s_cbranch_vccz L_ck_114
  s_mov_b32 s77, 0
L_poll_115:
  buffer_load_dword v243, v242, s[40:43], s76 offen sc1
  s_add_u32 s77, s77, 1
  s_waitcnt vmcnt(0)
  v_cmp_ne_u32 vcc, s70, v243
  s_cmp_ge_u32 s77, 400000
  s_cbranch_scc1 L_pdone_116
  s_cbranch_vccnz L_poll_115
L_pdone_116:
L_ck_114:
  s_add_u32 s8, s90, 4096
  buffer_load_dwordx4 v[24:27], v4, s[40:43], s8 offen sc1
  buffer_load_dwordx4 v[80:83], v6, s[40:43], s8 offen sc1
  v_mfma_f32_32x32x16_bf16 v[128:143], a[128:131], v[56:59], v[128:143]
  v_mfma_f32_32x32x16_bf16 v[144:159], a[128:131], v[112:115], v[144:159]
  v_mfma_f32_32x32x16_bf16 v[160:175], a[132:135], v[56:59], v[160:175]
  v_mfma_f32_32x32x16_bf16 v[176:191], a[132:135], v[112:115], v[176:191]
  s_add_u32 s8, s90, 5120
  buffer_load_dwordx4 v[28:31], v4, s[40:43], s8 offen sc1
  buffer_load_dwordx4 v[84:87], v6, s[40:43], s8 offen sc1
  v_mfma_f32_32x32x16_bf16 v[128:143], a[136:139], v[60:63], v[128:143]
  v_mfma_f32_32x32x16_bf16 v[144:159], a[136:139], v[116:119], v[144:159]
  v_mfma_f32_32x32x16_bf16 v[160:175], a[140:143], v[60:63], v[160:175]
  v_mfma_f32_32x32x16_bf16 v[176:191], a[140:143], v[116:119], v[176:191]
  s_add_u32 s8, s90, 6144
  buffer_load_dwordx4 v[32:35], v4, s[40:43], s8 offen sc1
  buffer_load_dwordx4 v[88:91], v6, s[40:43], s8 offen sc1
  s_waitcnt vmcnt(12)
  v_mfma_f32_32x32x16_bf16 v[128:143], a[168:171], v[64:67], v[128:143]
  v_mfma_f32_32x32x16_bf16 v[144:159], a[168:171], v[120:123], v[144:159]
  v_mfma_f32_32x32x16_bf16 v[160:175], a[172:175], v[64:67], v[160:175]
  v_mfma_f32_32x32x16_bf16 v[176:191], a[172:175], v[120:123], v[176:191]
  s_add_u32 s8, s90, 11264
  buffer_load_dwordx4 v[36:39], v4, s[40:43], s8 offen sc1
  buffer_load_dwordx4 v[92:95], v6, s[40:43], s8 offen sc1
  s_waitcnt vmcnt(12)
  v_mfma_f32_32x32x16_bf16 v[128:143], a[176:179], v[68:71], v[128:143]
  v_mfma_f32_32x32x16_bf16 v[144:159], a[176:179], v[124:127], v[144:159]
  v_mfma_f32_32x32x16_bf16 v[160:175], a[180:183], v[68:71], v[160:175]
  v_mfma_f32_32x32x16_bf16 v[176:191], a[180:183], v[124:127], v[176:191]
  s_add_u32 s8, s90, 12288
  buffer_load_dwordx4 v[40:43], v4, s[40:43], s8 offen sc1
  buffer_load_dwordx4 v[96:99], v6, s[40:43], s8 offen sc1
  s_waitcnt vmcnt(12)
  v_mfma_f32_32x32x16_bf16 v[128:143], a[184:187], v[16:19], v[128:143]
  v_mfma_f32_32x32x16_bf16 v[144:159], a[184:187], v[72:75], v[144:159]
  v_mfma_f32_32x32x16_bf16 v[160:175], a[188:191], v[16:19], v[160:175]
  v_mfma_f32_32x32x16_bf16 v[176:191], a[188:191], v[72:75], v[176:191]
  s_add_u32 s8, s90, 13312
  buffer_load_dwordx4 v[44:47], v4, s[40:43], s8 offen sc1
  buffer_load_dwordx4 v[100:103], v6, s[40:43], s8 offen sc1
  s_waitcnt vmcnt(12)
  v_mfma_f32_32x32x16_bf16 v[128:143], a[192:195], v[20:23], v[128:143]
  v_mfma_f32_32x32x16_bf16 v[144:159], a[192:195], v[76:79], v[144:159]
  v_mfma_f32_32x32x16_bf16 v[160:175], a[196:199], v[20:23], v[160:175]
  v_mfma_f32_32x32x16_bf16 v[176:191], a[196:199], v[76:79], v[176:191]
  s_add_u32 s8, s90, 18432
  buffer_load_dwordx4 v[48:51], v4, s[40:43], s8 offen sc1
  buffer_load_dwordx4 v[104:107], v6, s[40:43], s8 offen sc1
  s_waitcnt vmcnt(12)
  v_mfma_f32_32x32x16_bf16 v[128:143], a[32:35], v[24:27], v[128:143]
  v_mfma_f32_32x32x16_bf16 v[144:159], a[32:35], v[80:83], v[144:159]
  v_mfma_f32_32x32x16_bf16 v[160:175], a[36:39], v[24:27], v[160:175]
  v_mfma_f32_32x32x16_bf16 v[176:191], a[36:39], v[80:83], v[176:191]
  s_add_u32 s8, s90, 19456
  buffer_load_dwordx4 v[52:55], v4, s[40:43], s8 offen sc1
  buffer_load_dwordx4 v[108:111], v6, s[40:43], s8 offen sc1
  s_waitcnt vmcnt(12)
  v_mfma_f32_32x32x16_bf16 v[128:143], a[40:43], v[28:31], v[128:143]
  v_mfma_f32_32x32x16_bf16 v[144:159], a[40:43], v[84:87], v[144:159]
  v_mfma_f32_32x32x16_bf16 v[160:175], a[44:47], v[28:31], v[160:175]
  v_mfma_f32_32x32x16_bf16 v[176:191], a[44:47], v[84:87], v[176:191]
  s_add_u32 s8, s90, 20480
  buffer_load_dwordx4 v[56:59], v4, s[40:43], s8 offen sc1
  buffer_load_dwordx4 v[112:115], v6, s[40:43], s8 offen sc1
  s_waitcnt vmcnt(12)
  v_mfma_f32_32x32x16_bf16 v[128:143], a[48:51], v[32:35], v[128:143]
  v_mfma_f32_32x32x16_bf16 v[144:159], a[48:51], v[88:91], v[144:159]
  v_mfma_f32_32x32x16_bf16 v[160:175], a[52:55], v[32:35], v[160:175]
  v_mfma_f32_32x32x16_bf16 v[176:191], a[52:55], v[88:91], v[176:191]
  s_add_u32 s9, s69, 51200
  buffer_load_dwordx4 a[200:203], v4, s[40:43], s9 offen offset:0
  buffer_load_dwordx4 a[204:207], v4, s[40:43], s9 offen offset:1024
  s_add_u32 s8, s90, 25600
  buffer_load_dwordx4 v[60:63], v4, s[40:43], s8 offen sc1
  buffer_load_dwordx4 v[116:119], v6, s[40:43], s8 offen sc1
  s_waitcnt vmcnt(14)
  v_mfma_f32_32x32x16_bf16 v[128:143], a[88:91], v[36:39], v[128:143]
  v_mfma_f32_32x32x16_bf16 v[144:159], a[88:91], v[92:95], v[144:159]
  v_mfma_f32_32x32x16_bf16 v[160:175], a[92:95], v[36:39], v[160:175]
  v_mfma_f32_32x32x16_bf16 v[176:191], a[92:95], v[92:95], v[176:191]
  s_add_u32 s9, s69, 53248
  buffer_load_dwordx4 a[208:211], v4, s[40:43], s9 offen offset:0
  buffer_load_dwordx4 a[212:215], v4, s[40:43], s9 offen offset:1024
  s_add_u32 s8, s90, 26624
  buffer_load_dwordx4 v[64:67], v4, s[40:43], s8 offen sc1
  buffer_load_dwordx4 v[120:123], v6, s[40:43], s8 offen sc1
  s_waitcnt vmcnt(16)
  v_mfma_f32_32x32x16_bf16 v[128:143], a[96:99], v[40:43], v[128:143]
  v_mfma_f32_32x32x16_bf16 v[144:159], a[96:99], v[96:99], v[144:159]
  v_mfma_f32_32x32x16_bf16 v[160:175], a[100:103], v[40:43], v[160:175]
  v_mfma_f32_32x32x16_bf16 v[176:191], a[100:103], v[96:99], v[176:191]
  s_add_u32 s9, s69, 55296
  buffer_load_dwordx4 a[216:219], v4, s[40:43], s9 offen offset:0
  buffer_load_dwordx4 a[220:223], v4, s[40:43], s9 offen offset:1024
  s_add_u32 s8, s90, 27648
  buffer_load_dwordx4 v[68:71], v4, s[40:43], s8 offen sc1
  buffer_load_dwordx4 v[124:127], v6, s[40:43], s8 offen sc1
  s_waitcnt vmcnt(18)
  v_mfma_f32_32x32x16_bf16 v[128:143], a[104:107], v[44:47], v[128:143]
  v_mfma_f32_32x32x16_bf16 v[144:159], a[104:107], v[100:103], v[144:159]
  v_mfma_f32_32x32x16_bf16 v[160:175], a[108:111], v[44:47], v[160:175]
  v_mfma_f32_32x32x16_bf16 v[176:191], a[108:111], v[100:103], v[176:191]
  s_waitcnt vmcnt(16)
  v_mfma_f32_32x32x16_bf16 v[128:143], a[144:147], v[48:51], v[128:143]
  v_mfma_f32_32x32x16_bf16 v[144:159], a[144:147], v[104:107], v[144:159]
  v_mfma_f32_32x32x16_bf16 v[160:175], a[148:151], v[48:51], v[160:175]
  v_mfma_f32_32x32x16_bf16 v[176:191], a[148:151], v[104:107], v[176:191]
  s_waitcnt vmcnt(14)
  v_mfma_f32_32x32x16_bf16 v[128:143], a[152:155], v[52:55], v[128:143]
  v_mfma_f32_32x32x16_bf16 v[144:159], a[152:155], v[108:111], v[144:159]
  v_mfma_f32_32x32x16_bf16 v[160:175], a[156:159], v[52:55], v[160:175]
  v_mfma_f32_32x32x16_bf16 v[176:191], a[156:159], v[108:111], v[176:191]
  s_waitcnt vmcnt(12)
  v_mfma_f32_32x32x16_bf16 v[128:143], a[160:163], v[56:59], v[128:143]
  v_mfma_f32_32x32x16_bf16 v[144:159], a[160:163], v[112:115], v[144:159]
  v_mfma_f32_32x32x16_bf16 v[160:175], a[164:167], v[56:59], v[160:175]
  v_mfma_f32_32x32x16_bf16 v[176:191], a[164:167], v[112:115], v[176:191]
  s_waitcnt vmcnt(10)
  s_waitcnt vmcnt(8)
  v_mfma_f32_32x32x16_bf16 v[128:143], a[200:203], v[60:63], v[128:143]
  v_mfma_f32_32x32x16_bf16 v[144:159], a[200:203], v[116:119], v[144:159]
  v_mfma_f32_32x32x16_bf16 v[160:175], a[204:207], v[60:63], v[160:175]
  v_mfma_f32_32x32x16_bf16 v[176:191], a[204:207], v[116:119], v[176:191]
  s_waitcnt vmcnt(6)
  s_waitcnt vmcnt(4)
  v_mfma_f32_32x32x16_bf16 v[128:143], a[208:211], v[64:67], v[128:143]
  v_mfma_f32_32x32x16_bf16 v[144:159], a[208:211], v[120:123], v[144:159]
  v_mfma_f32_32x32x16_bf16 v[160:175], a[212:215], v[64:67], v[160:175]
  v_mfma_f32_32x32x16_bf16 v[176:191], a[212:215], v[120:123], v[176:191]
  s_waitcnt vmcnt(2)
  s_waitcnt vmcnt(0)
  v_mfma_f32_32x32x16_bf16 v[128:143], a[216:219], v[68:71], v[128:143]
  v_mfma_f32_32x32x16_bf16 v[144:159], a[216:219], v[124:127], v[144:159]
  v_mfma_f32_32x32x16_bf16 v[160:175], a[220:223], v[68:71], v[160:175]
  v_mfma_f32_32x32x16_bf16 v[176:191], a[220:223], v[124:127], v[176:191]
  s_lshr_b32 s10, s3, 1
  s_and_b32 s11, s3, 1
  s_add_u32 s8, s13, s11
  s_lshl_b32 s8, s8, 5
  s_mul_i32 s8, s8, 896
  s_lshl_b32 s7, s14, 7
  s_add_u32 s8, s8, s7
  s_lshl_b32 s10, s10, 6
  s_add_u32 s8, s8, s10
  v_and_b32 v8, 31, v0
  v_mul_u32_u24 v8, 896, v8
  v_lshrrev_b32 v9, 5, v0
  v_lshl_add_u32 v8, v9, 4, v8
  s_add_u32 s9, s8, 12582912
  s_cmp_eq_u32 s95, 0
  s_cselect_b32 s9, 0x7ffffff0, s9
  buffer_load_dwordx4 v[16:19], v8, s[40:43], s9 offen sc1
  buffer_load_dwordx4 v[20:23], v8, s[40:43], s9 offen offset:32 sc1
  v_add_u32 v7, 100352, v4
  s_nop 7
  s_cmp_eq_u32 s3, 1
  s_cbranch_scc1 L_g2w_119
  s_cmp_eq_u32 s3, 2
  s_cbranch_scc1 L_g2w_120
  s_cmp_eq_u32 s3, 3
  s_cbranch_scc1 L_g2w_121
L_g2w_118:
  ds_write_b128 v7, v[144:147] offset:20480
  ds_write_b128 v7, v[148:151] offset:21504
  ds_write_b128 v7, v[152:155] offset:22528
  ds_write_b128 v7, v[156:159] offset:23552
  ds_write_b128 v7, v[160:163] offset:28672
  ds_write_b128 v7, v[164:167] offset:29696
  ds_write_b128 v7, v[168:171] offset:30720
  ds_write_b128 v7, v[172:175] offset:31744
  ds_write_b128 v7, v[176:179] offset:36864
  ds_write_b128 v7, v[180:183] offset:37888
  ds_write_b128 v7, v[184:187] offset:38912
  ds_write_b128 v7, v[188:191] offset:39936
  v_mov_b64 v[32:33], v[128:129]
  v_mov_b64 v[34:35], v[130:131]
  v_mov_b64 v[36:37], v[132:133]
  v_mov_b64 v[38:39], v[134:135]
  v_mov_b64 v[40:41], v[136:137]
  v_mov_b64 v[42:43], v[138:139]
  v_mov_b64 v[44:45], v[140:141]
  v_mov_b64 v[46:47], v[142:143]
  s_branch L_g2d_117
L_g2w_119:
  ds_write_b128 v7, v[128:131] offset:0
  ds_write_b128 v7, v[132:135] offset:1024
  ds_write_b128 v7, v[136:139] offset:2048
  ds_write_b128 v7, v[140:143] offset:3072
  ds_write_b128 v7, v[160:163] offset:32768
  ds_write_b128 v7, v[164:167] offset:33792
  ds_write_b128 v7, v[168:171] offset:34816
  ds_write_b128 v7, v[172:175] offset:35840
  ds_write_b128 v7, v[176:179] offset:40960
  ds_write_b128 v7, v[180:183] offset:41984
  ds_write_b128 v7, v[184:187] offset:43008
  ds_write_b128 v7, v[188:191] offset:44032
  v_mov_b64 v[32:33], v[144:145]
  v_mov_b64 v[34:35], v[146:147]
  v_mov_b64 v[36:37], v[148:149]
  v_mov_b64 v[38:39], v[150:151]
  v_mov_b64 v[40:41], v[152:153]
  v_mov_b64 v[42:43], v[154:155]
  v_mov_b64 v[44:45], v[156:157]
  v_mov_b64 v[46:47], v[158:159]
  s_branch L_g2d_117
L_g2w_120:
  ds_write_b128 v7, v[128:131] offset:4096
  ds_write_b128 v7, v[132:135] offset:5120
  ds_write_b128 v7, v[136:139] offset:6144
  ds_write_b128 v7, v[140:143] offset:7168
  ds_write_b128 v7, v[144:147] offset:12288
  ds_write_b128 v7, v[148:151] offset:13312
  ds_write_b128 v7, v[152:155] offset:14336
  ds_write_b128 v7, v[156:159] offset:15360
  ds_write_b128 v7, v[176:179] offset:45056
  ds_write_b128 v7, v[180:183] offset:46080
  ds_write_b128 v7, v[184:187] offset:47104
  ds_write_b128 v7, v[188:191] offset:48128
  v_mov_b64 v[32:33], v[160:161]
  v_mov_b64 v[34:35], v[162:163]
  v_mov_b64 v[36:37], v[164:165]
  v_mov_b64 v[38:39], v[166:167]
  v_mov_b64 v[40:41], v[168:169]
  v_mov_b64 v[42:43], v[170:171]
  v_mov_b64 v[44:45], v[172:173]
  v_mov_b64 v[46:47], v[174:175]
  s_branch L_g2d_117
L_g2w_121:
  ds_write_b128 v7, v[128:131] offset:8192
  ds_write_b128 v7, v[132:135] offset:9216
  ds_write_b128 v7, v[136:139] offset:10240
  ds_write_b128 v7, v[140:143] offset:11264
  ds_write_b128 v7, v[144:147] offset:16384
  ds_write_b128 v7, v[148:151] offset:17408
  ds_write_b128 v7, v[152:155] offset:18432
  ds_write_b128 v7, v[156:159] offset:19456
  ds_write_b128 v7, v[160:163] offset:24576
  ds_write_b128 v7, v[164:167] offset:25600
  ds_write_b128 v7, v[168:171] offset:26624
  ds_write_b128 v7, v[172:175] offset:27648
  v_mov_b64 v[32:33], v[176:177]
  v_mov_b64 v[34:35], v[178:179]
  v_mov_b64 v[36:37], v[180:181]
  v_mov_b64 v[38:39], v[182:183]
  v_mov_b64 v[40:41], v[184:185]
  v_mov_b64 v[42:43], v[186:187]
  v_mov_b64 v[44:45], v[188:189]
  v_mov_b64 v[46:47], v[190:191]
L_g2d_117:
  s_mul_i32 s10, s3, 12288
  v_add_u32 v7, s10, v7
  s_waitcnt lgkmcnt(0)
  s_barrier
  ds_read_b128 v[48:51], v7 offset:0
  ds_read_b128 v[52:55], v7 offset:1024
  ds_read_b128 v[56:59], v7 offset:2048
  ds_read_b128 v[60:63], v7 offset:3072
  ds_read_b128 v[64:67], v7 offset:4096
  ds_read_b128 v[68:71], v7 offset:5120
  ds_read_b128 v[72:75], v7 offset:6144
  ds_read_b128 v[76:79], v7 offset:7168
  ds_read_b128 v[80:83], v7 offset:8192
  ds_read_b128 v[84:87], v7 offset:9216
  ds_read_b128 v[88:91], v7 offset:10240
  ds_read_b128 v[92:95], v7 offset:11264
  s_waitcnt lgkmcnt(8)
  v_pk_add_f32 v[32:33], v[32:33], v[48:49]
  v_pk_add_f32 v[34:35], v[34:35], v[50:51]
  v_pk_add_f32 v[36:37], v[36:37], v[52:53]
  v_pk_add_f32 v[38:39], v[38:39], v[54:55]
  v_pk_add_f32 v[40:41], v[40:41], v[56:57]
  v_pk_add_f32 v[42:43], v[42:43], v[58:59]
  v_pk_add_f32 v[44:45], v[44:45], v[60:61]
  v_pk_add_f32 v[46:47], v[46:47], v[62:63]
  s_waitcnt lgkmcnt(4)
  v_pk_add_f32 v[32:33], v[32:33], v[64:65]
  v_pk_add_f32 v[34:35], v[34:35], v[66:67]
  v_pk_add_f32 v[36:37], v[36:37], v[68:69]
  v_pk_add_f32 v[38:39], v[38:39], v[70:71]
  v_pk_add_f32 v[40:41], v[40:41], v[72:73]
  v_pk_add_f32 v[42:43], v[42:43], v[74:75]
  v_pk_add_f32 v[44:45], v[44:45], v[76:77]
  v_pk_add_f32 v[46:47], v[46:47], v[78:79]
  s_waitcnt lgkmcnt(0)
  v_pk_add_f32 v[32:33], v[32:33], v[80:81]
  v_pk_add_f32 v[34:35], v[34:35], v[82:83]
  v_pk_add_f32 v[36:37], v[36:37], v[84:85]
  v_pk_add_f32 v[38:39], v[38:39], v[86:87]
  v_pk_add_f32 v[40:41], v[40:41], v[88:89]
  v_pk_add_f32 v[42:43], v[42:43], v[90:91]
  v_pk_add_f32 v[44:45], v[44:45], v[92:93]
  v_pk_add_f32 v[46:47], v[46:47], v[94:95]
  v_cvt_pk_bf16_f32 v24, v32, v33
  v_cvt_pk_bf16_f32 v25, v34, v35
  v_cvt_pk_bf16_f32 v26, v36, v37
  v_cvt_pk_bf16_f32 v27, v38, v39
  v_cvt_pk_bf16_f32 v28, v40, v41
  v_cvt_pk_bf16_f32 v29, v42, v43
  v_cvt_pk_bf16_f32 v30, v44, v45
  v_cvt_pk_bf16_f32 v31, v46, v47
  s_nop 1
  v_permlane32_swap_b32 v24, v26
  v_permlane32_swap_b32 v25, v27
  v_permlane32_swap_b32 v28, v30
  v_permlane32_swap_b32 v29, v31
  s_cmp_eq_u32 s95, 0
  s_cbranch_scc1 L_g2l0_122
  s_mov_b32 s44, s34
  s_mov_b32 s45, s35
  s_mov_b32 s46, 0x1c0000
  s_mov_b32 s47, 0x20000
  s_waitcnt vmcnt(0)
  v_lshlrev_b32 v32, 16, v24
  v_and_b32 v33, s12, v24
  v_lshlrev_b32 v34, 16, v25
  v_and_b32 v35, s12, v25
  v_lshlrev_b32 v36, 16, v26
  v_and_b32 v37, s12, v26
  v_lshlrev_b32 v38, 16, v27
  v_and_b32 v39, s12, v27
  v_lshlrev_b32 v40, 16, v28
  v_and_b32 v41, s12, v28
  v_lshlrev_b32 v42, 16, v29
  v_and_b32 v43, s12, v29
  v_lshlrev_b32 v44, 16, v30
  v_and_b32 v45, s12, v30
  v_lshlrev_b32 v46, 16, v31
  v_and_b32 v47, s12, v31
  v_lshlrev_b32 v48, 16, v16
  v_and_b32 v49, s12, v16
  v_lshlrev_b32 v50, 16, v17
  v_and_b32 v51, s12, v17
  v_lshlrev_b32 v52, 16, v18
  v_and_b32 v53, s12, v18
  v_lshlrev_b32 v54, 16, v19
  v_and_b32 v55, s12, v19
  v_lshlrev_b32 v56, 16, v20
  v_and_b32 v57, s12, v20
  v_lshlrev_b32 v58, 16, v21
  v_and_b32 v59, s12, v21
  v_lshlrev_b32 v60, 16, v22
  v_and_b32 v61, s12, v22
  v_lshlrev_b32 v62, 16, v23
  v_and_b32 v63, s12, v23
  v_pk_add_f32 v[32:33], v[32:33], v[48:49]
  v_cvt_pk_bf16_f32 v24, v32, v33
  v_pk_add_f32 v[34:35], v[34:35], v[50:51]
  v_cvt_pk_bf16_f32 v25, v34, v35
  v_pk_add_f32 v[36:37], v[36:37], v[52:53]
  v_cvt_pk_bf16_f32 v26, v36, v37
  v_pk_add_f32 v[38:39], v[38:39], v[54:55]
  v_cvt_pk_bf16_f32 v27, v38, v39
  v_pk_add_f32 v[40:41], v[40:41], v[56:57]
  v_cvt_pk_bf16_f32 v28, v40, v41
  v_pk_add_f32 v[42:43], v[42:43], v[58:59]
  v_cvt_pk_bf16_f32 v29, v42, v43
  v_pk_add_f32 v[44:45], v[44:45], v[60:61]
  v_cvt_pk_bf16_f32 v30, v44, v45
  v_pk_add_f32 v[46:47], v[46:47], v[62:63]
  v_cvt_pk_bf16_f32 v31, v46, v47
  buffer_store_dwordx4 v[24:27], v8, s[44:47], s8 offen
  buffer_store_dwordx4 v[28:31], v8, s[44:47], s8 offen offset:32
  s_branch L_nog2_92
L_g2l0_122:
  s_add_u32 s8, s8, 12582912
  s_cmp_lg_u32 s67, 0
  s_cbranch_scc1 L_fast_123
  buffer_store_dwordx4 v[24:27], v8, s[40:43], s8 offen sc1
  buffer_store_dwordx4 v[28:31], v8, s[40:43], s8 offen offset:32 sc1
  s_branch L_sdone_124
L_fast_123:
  buffer_store_dwordx4 v[24:27], v8, s[40:43], s8 offen
  buffer_store_dwordx4 v[28:31], v8, s[40:43], s8 offen offset:32
L_sdone_124:
  s_add_u32 s76, s71, 12288
  s_waitcnt vmcnt(0)
  s_cmp_lg_u32 s67, 0
  s_cbranch_scc1 L_fast_125
  buffer_store_dword v245, v246, s[40:43], s76 offen sc1
  s_branch L_sdone_126
L_fast_125:
  buffer_store_dword v245, v246, s[40:43], s76 offen
L_sdone_126:
L_nog2_92:
  s_lshr_b32 s77, s5, 3
  s_mul_i32 s77, s77, 28
  s_bfe_u32 s6, s5, 0x10002
  s_add_u32 s77, s77, s6
  v_min_u32 v242, 13, v0
  v_lshl_add_u32 v242, v242, 1, s77
  v_lshlrev_b32 v242, 2, v242
  s_add_u32 s76, s71, 12288
  s_mov_b32 s77, 0
L_poll_127:
  buffer_load_dword v243, v242, s[40:43], s76 offen sc1
  s_add_u32 s77, s77, 1
  s_waitcnt vmcnt(0)
  v_cmp_ne_u32 vcc, s70, v243
  s_cmp_ge_u32 s77, 400000
  s_cbranch_scc1 L_pdone_128
  s_cbranch_vccnz L_poll_127
L_pdone_128:
  s_mov_b32 s6, 12582912
  buffer_load_dwordx4 v[4:7], v200, s[40:43], s6 offen sc1
  buffer_load_dwordx4 v[8:11], v200, s[40:43], s6 offen offset:896 sc1
  s_waitcnt vmcnt(1)
  v_lshlrev_b32 v226, 16, v4
  v_and_b32 v227, s12, v4
  v_lshlrev_b32 v228, 16, v5
  v_and_b32 v229, s12, v5
  v_lshlrev_b32 v230, 16, v6
  v_and_b32 v231, s12, v6
  v_lshlrev_b32 v232, 16, v7
  v_and_b32 v233, s12, v7
  s_waitcnt vmcnt(0)
  v_lshlrev_b32 v234, 16, v8
  v_and_b32 v235, s12, v8
  v_lshlrev_b32 v236, 16, v9
  v_and_b32 v237, s12, v9
  v_lshlrev_b32 v238, 16, v10
  v_and_b32 v239, s12, v10
  v_lshlrev_b32 v240, 16, v11
  v_and_b32 v241, s12, v11
  v_pk_add_f32 v[210:211], v[210:211], v[226:227]
  v_cvt_pk_bf16_f32 v210, v210, v211
  v_and_b32 v211, s12, v210
  v_lshlrev_b32 v210, 16, v210
  v_pk_add_f32 v[212:213], v[212:213], v[228:229]
  v_cvt_pk_bf16_f32 v212, v212, v213
  v_and_b32 v213, s12, v212
  v_lshlrev_b32 v212, 16, v212
  v_pk_add_f32 v[214:215], v[214:215], v[230:231]
  v_cvt_pk_bf16_f32 v214, v214, v215
  v_and_b32 v215, s12, v214
  v_lshlrev_b32 v214, 16, v214
  v_pk_add_f32 v[216:217], v[216:217], v[232:233]
  v_cvt_pk_bf16_f32 v216, v216, v217
  v_and_b32 v217, s12, v216
  v_lshlrev_b32 v216, 16, v216
  v_pk_add_f32 v[218:219], v[218:219], v[234:235]
  v_cvt_pk_bf16_f32 v218, v218, v219
  v_and_b32 v219, s12, v218
  v_lshlrev_b32 v218, 16, v218
  v_pk_add_f32 v[220:221], v[220:221], v[236:237]
  v_cvt_pk_bf16_f32 v220, v220, v221
  v_and_b32 v221, s12, v220
  v_lshlrev_b32 v220, 16, v220
  v_pk_add_f32 v[222:223], v[222:223], v[238:239]
  v_cvt_pk_bf16_f32 v222, v222, v223
  v_and_b32 v223, s12, v222
  v_lshlrev_b32 v222, 16, v222
  v_pk_add_f32 v[224:225], v[224:225], v[240:241]
  v_cvt_pk_bf16_f32 v224, v224, v225
  v_and_b32 v225, s12, v224
  v_lshlrev_b32 v224, 16, v224
  s_nop 0
  v_readfirstlane_b32 s56, v210
  v_readfirstlane_b32 s57, v210
  v_readfirstlane_b32 s58, v218
  v_readfirstlane_b32 s59, v218
  s_mov_b32 s64, 0x3b124925
  v_pk_add_f32 v[226:227], v[210:211], s[56:57] neg_lo:[0,1] neg_hi:[0,1]
  v_pk_add_f32 v[228:229], v[212:213], s[56:57] neg_lo:[0,1] neg_hi:[0,1]
  v_pk_add_f32 v[230:231], v[214:215], s[56:57] neg_lo:[0,1] neg_hi:[0,1]
  v_pk_add_f32 v[232:233], v[216:217], s[56:57] neg_lo:[0,1] neg_hi:[0,1]
  v_pk_add_f32 v[234:235], v[218:219], s[58:59] neg_lo:[0,1] neg_hi:[0,1]
  v_pk_add_f32 v[236:237], v[220:221], s[58:59] neg_lo:[0,1] neg_hi:[0,1]
  v_pk_add_f32 v[238:239], v[222:223], s[58:59] neg_lo:[0,1] neg_hi:[0,1]
  v_pk_add_f32 v[240:241], v[224:225], s[58:59] neg_lo:[0,1] neg_hi:[0,1]
  v_pk_add_f32 v[20:21], v[226:227], v[228:229]
  v_pk_mul_f32 v[22:23], v[226:227], v[226:227]
  v_pk_add_f32 v[20:21], v[20:21], v[230:231]
  v_pk_add_f32 v[20:21], v[20:21], v[232:233]
  v_pk_fma_f32 v[22:23], v[228:229], v[228:229], v[22:23]
  v_pk_fma_f32 v[22:23], v[230:231], v[230:231], v[22:23]
  v_pk_fma_f32 v[22:23], v[232:233], v[232:233], v[22:23]
  v_pk_add_f32 v[24:25], v[234:235], v[236:237]
  v_pk_mul_f32 v[26:27], v[234:235], v[234:235]
  v_pk_add_f32 v[24:25], v[24:25], v[238:239]
  v_pk_add_f32 v[24:25], v[24:25], v[240:241]
  v_pk_fma_f32 v[26:27], v[236:237], v[236:237], v[26:27]
  v_pk_fma_f32 v[26:27], v[238:239], v[238:239], v[26:27]
  v_pk_fma_f32 v[26:27], v[240:241], v[240:241], v[26:27]
  v_add_f32 v20, v20, v21
  v_add_f32 v21, v22, v23
  v_add_f32 v24, v24, v25
  v_add_f32 v25, v26, v27
  v_mul_f32 v20, v201, v20
  v_mul_f32 v21, v201, v21
  v_mul_f32 v24, v201, v24
  v_mul_f32 v25, v201, v25
  v_add_f32_dpp v20, v20, v20 quad_perm:[1,0,3,2] row_mask:0xf bank_mask:0xf
  v_add_f32_dpp v21, v21, v21 quad_perm:[1,0,3,2] row_mask:0xf bank_mask:0xf
  v_add_f32_dpp v24, v24, v24 quad_perm:[1,0,3,2] row_mask:0xf bank_mask:0xf
  v_add_f32_dpp v25, v25, v25 quad_perm:[1,0,3,2] row_mask:0xf bank_mask:0xf
  v_add_f32_dpp v20, v20, v20 quad_perm:[2,3,0,1] row_mask:0xf bank_mask:0xf
  v_add_f32_dpp v21, v21, v21 quad_perm:[2,3,0,1] row_mask:0xf bank_mask:0xf
  v_add_f32_dpp v24, v24, v24 quad_perm:[2,3,0,1] row_mask:0xf bank_mask:0xf
  v_add_f32_dpp v25, v25, v25 quad_perm:[2,3,0,1] row_mask:0xf bank_mask:0xf
  v_add_f32_dpp v20, v20, v20 row_half_mirror row_mask:0xf bank_mask:0xf
  v_add_f32_dpp v21, v21, v21 row_half_mirror row_mask:0xf bank_mask:0xf
  v_add_f32_dpp v24, v24, v24 row_half_mirror row_mask:0xf bank_mask:0xf
  v_add_f32_dpp v25, v25, v25 row_half_mirror row_mask:0xf bank_mask:0xf
  v_add_f32_dpp v20, v20, v20 row_mirror row_mask:0xf bank_mask:0xf
  v_add_f32_dpp v21, v21, v21 row_mirror row_mask:0xf bank_mask:0xf
  v_add_f32_dpp v24, v24, v24 row_mirror row_mask:0xf bank_mask:0xf
  v_add_f32_dpp v25, v25, v25 row_mirror row_mask:0xf bank_mask:0xf
  v_add_f32_dpp v20, v20, v20 row_bcast:15 row_mask:0xa bank_mask:0xf
  v_add_f32_dpp v21, v21, v21 row_bcast:15 row_mask:0xa bank_mask:0xf
  v_add_f32_dpp v24, v24, v24 row_bcast:15 row_mask:0xa bank_mask:0xf
  v_add_f32_dpp v25, v25, v25 row_bcast:15 row_mask:0xa bank_mask:0xf
  v_add_f32_dpp v20, v20, v20 row_bcast:31 row_mask:0xc bank_mask:0xf
  v_add_f32_dpp v21, v21, v21 row_bcast:31 row_mask:0xc bank_mask:0xf
  v_add_f32_dpp v24, v24, v24 row_bcast:31 row_mask:0xc bank_mask:0xf
  v_add_f32_dpp v25, v25, v25 row_bcast:31 row_mask:0xc bank_mask:0xf
  v_readlane_b32 s60, v20, 63
  v_readlane_b32 s61, v21, 63
  v_readlane_b32 s62, v24, 63
  v_readlane_b32 s63, v25, 63
  v_mov_b32 v28, s64
  v_mul_f32 v20, s60, v28
  v_mul_f32 v21, s62, v28
  v_mul_f32 v22, s61, v28
  v_mul_f32 v23, s63, v28
  v_pk_fma_f32 v[22:23], v[20:21], v[20:21], v[22:23] neg_lo:[1,0,0] neg_hi:[1,0,0]
  v_add_f32 v20, s56, v20
  v_add_f32 v21, s58, v21
  v_max_f32 v22, 0, v22
  v_max_f32 v23, 0, v23
  v_cvt_pk_bf16_f32 v20, v20, v21
  v_and_b32 v21, s12, v20
  v_lshlrev_b32 v20, 16, v20
  v_cvt_pk_bf16_f32 v22, v22, v23
  v_and_b32 v23, s12, v22
  v_lshlrev_b32 v22, 16, v22
  v_add_f32 v22, 0x3727c5ac, v22
  v_add_f32 v23, 0x3727c5ac, v23
  v_cvt_pk_bf16_f32 v22, v22, v23
  v_and_b32 v23, s12, v22
  v_lshlrev_b32 v22, 16, v22
  v_sqrt_f32 v22, v22
  v_sqrt_f32 v23, v23
  v_pk_add_f32 v[226:227], v[210:211], v[20:21] op_sel_hi:[1,0] neg_lo:[0,1] neg_hi:[0,1]
  v_pk_add_f32 v[228:229], v[212:213], v[20:21] op_sel_hi:[1,0] neg_lo:[0,1] neg_hi:[0,1]
  v_pk_add_f32 v[230:231], v[214:215], v[20:21] op_sel_hi:[1,0] neg_lo:[0,1] neg_hi:[0,1]
  v_pk_add_f32 v[232:233], v[216:217], v[20:21] op_sel_hi:[1,0] neg_lo:[0,1] neg_hi:[0,1]
  v_cvt_pk_bf16_f32 v22, v22, v23
  v_and_b32 v23, s12, v22
  v_lshlrev_b32 v22, 16, v22
  v_rcp_f32 v24, v22
  v_rcp_f32 v25, v23
  v_pk_add_f32 v[234:235], v[218:219], v[20:21] op_sel:[0,1] op_sel_hi:[1,1] neg_lo:[0,1] neg_hi:[0,1]
  v_pk_add_f32 v[236:237], v[220:221], v[20:21] op_sel:[0,1] op_sel_hi:[1,1] neg_lo:[0,1] neg_hi:[0,1]
  v_pk_add_f32 v[238:239], v[222:223], v[20:21] op_sel:[0,1] op_sel_hi:[1,1] neg_lo:[0,1] neg_hi:[0,1]
  v_pk_add_f32 v[240:241], v[224:225], v[20:21] op_sel:[0,1] op_sel_hi:[1,1] neg_lo:[0,1] neg_hi:[0,1]
  v_fma_f32 v26, -v22, v24, 1.0
  v_fma_f32 v27, -v23, v25, 1.0
  v_pk_fma_f32 v[24:25], v[26:27], v[24:25], v[24:25]
  v_cvt_pk_bf16_f32 v226, v226, v227
  v_and_b32 v227, s12, v226
  v_lshlrev_b32 v226, 16, v226
  v_pk_mul_f32 v[226:227], v[226:227], v[24:25] op_sel_hi:[1,0]
  v_cvt_pk_bf16_f32 v226, v226, v227
  v_and_b32 v227, s12, v226
  v_lshlrev_b32 v226, 16, v226
  v_cvt_pk_bf16_f32 v228, v228, v229
  v_and_b32 v229, s12, v228
  v_lshlrev_b32 v228, 16, v228
  v_pk_mul_f32 v[228:229], v[228:229], v[24:25] op_sel_hi:[1,0]
  v_cvt_pk_bf16_f32 v228, v228, v229
  v_and_b32 v229, s12, v228
  v_lshlrev_b32 v228, 16, v228
  v_cvt_pk_bf16_f32 v230, v230, v231
  v_and_b32 v231, s12, v230
  v_lshlrev_b32 v230, 16, v230
  v_pk_mul_f32 v[230:231], v[230:231], v[24:25] op_sel_hi:[1,0]
  v_cvt_pk_bf16_f32 v230, v230, v231
  v_and_b32 v231, s12, v230
  v_lshlrev_b32 v230, 16, v230
  v_cvt_pk_bf16_f32 v232, v232, v233
  v_and_b32 v233, s12, v232
  v_lshlrev_b32 v232, 16, v232
  v_pk_mul_f32 v[232:233], v[232:233], v[24:25] op_sel_hi:[1,0]
  v_cvt_pk_bf16_f32 v232, v232, v233
  v_and_b32 v233, s12, v232
  v_lshlrev_b32 v232, 16, v232
  v_cvt_pk_bf16_f32 v234, v234, v235
  v_and_b32 v235, s12, v234
  v_lshlrev_b32 v234, 16, v234
  v_pk_mul_f32 v[234:235], v[234:235], v[24:25] op_sel:[0,1] op_sel_hi:[1,1]
  v_cvt_pk_bf16_f32 v234, v234, v235
  v_and_b32 v235, s12, v234
  v_lshlrev_b32 v234, 16, v234
  v_cvt_pk_bf16_f32 v236, v236, v237
  v_and_b32 v237, s12, v236
  v_lshlrev_b32 v236, 16, v236
  v_pk_mul_f32 v[236:237], v[236:237], v[24:25] op_sel:[0,1] op_sel_hi:[1,1]
  v_cvt_pk_bf16_f32 v236, v236, v237
  v_and_b32 v237, s12, v236
  v_lshlrev_b32 v236, 16, v236
  v_cvt_pk_bf16_f32 v238, v238, v239
  v_and_b32 v239, s12, v238
  v_lshlrev_b32 v238, 16, v238
  v_pk_mul_f32 v[238:239], v[238:239], v[24:25] op_sel:[0,1] op_sel_hi:[1,1]
  v_cvt_pk_bf16_f32 v238, v238, v239
  v_and_b32 v239, s12, v238
  v_lshlrev_b32 v238, 16, v238
  v_cvt_pk_bf16_f32 v240, v240, v241
  v_and_b32 v241, s12, v240
  v_lshlrev_b32 v240, 16, v240
  v_pk_mul_f32 v[240:241], v[240:241], v[24:25] op_sel:[0,1] op_sel_hi:[1,1]
  v_cvt_pk_bf16_f32 v240, v240, v241
  v_and_b32 v241, s12, v240
  v_lshlrev_b32 v240, 16, v240
  v_lshlrev_b32 v40, 16, v202
  v_lshlrev_b32 v41, 16, v203
  v_lshlrev_b32 v42, 16, v204
  v_lshlrev_b32 v43, 16, v205
  v_lshlrev_b32 v44, 16, v206
  v_lshlrev_b32 v45, 16, v207
  v_lshlrev_b32 v46, 16, v208
  v_lshlrev_b32 v47, 16, v209
  v_pk_mul_f32 v[226:227], v[226:227], v[40:41]
  v_cvt_pk_bf16_f32 v226, v226, v227
  v_and_b32 v227, s12, v226
  v_lshlrev_b32 v226, 16, v226
  v_pk_add_f32 v[210:211], v[210:211], v[226:227]
  v_cvt_pk_bf16_f32 v210, v210, v211
  v_and_b32 v211, s12, v210
  v_lshlrev_b32 v210, 16, v210
  v_pk_mul_f32 v[228:229], v[228:229], v[42:43]
  v_cvt_pk_bf16_f32 v228, v228, v229
  v_and_b32 v229, s12, v228
  v_lshlrev_b32 v228, 16, v228
  v_pk_add_f32 v[212:213], v[212:213], v[228:229]
  v_cvt_pk_bf16_f32 v212, v212, v213
  v_and_b32 v213, s12, v212
  v_lshlrev_b32 v212, 16, v212
  v_pk_mul_f32 v[230:231], v[230:231], v[44:45]
  v_cvt_pk_bf16_f32 v230, v230, v231
  v_and_b32 v231, s12, v230
  v_lshlrev_b32 v230, 16, v230
  v_pk_add_f32 v[214:215], v[214:215], v[230:231]
  v_cvt_pk_bf16_f32 v214, v214, v215
  v_and_b32 v215, s12, v214
  v_lshlrev_b32 v214, 16, v214
  v_pk_mul_f32 v[232:233], v[232:233], v[46:47]
  v_cvt_pk_bf16_f32 v232, v232, v233
  v_and_b32 v233, s12, v232
  v_lshlrev_b32 v232, 16, v232
  v_pk_add_f32 v[216:217], v[216:217], v[232:233]
  v_cvt_pk_bf16_f32 v216, v216, v217
  v_and_b32 v217, s12, v216
  v_lshlrev_b32 v216, 16, v216
  v_and_b32 v40, s12, v202
  v_and_b32 v41, s12, v203
  v_and_b32 v42, s12, v204
  v_and_b32 v43, s12, v205
  v_and_b32 v44, s12, v206
  v_and_b32 v45, s12, v207
  v_and_b32 v46, s12, v208
  v_and_b32 v47, s12, v209
  v_pk_mul_f32 v[234:235], v[234:235], v[40:41]
  v_cvt_pk_bf16_f32 v234, v234, v235
  v_and_b32 v235, s12, v234
  v_lshlrev_b32 v234, 16, v234
  v_pk_add_f32 v[218:219], v[218:219], v[234:235]
  v_cvt_pk_bf16_f32 v218, v218, v219
  v_and_b32 v219, s12, v218
  v_lshlrev_b32 v218, 16, v218
  v_pk_mul_f32 v[236:237], v[236:237], v[42:43]
  v_cvt_pk_bf16_f32 v236, v236, v237
  v_and_b32 v237, s12, v236
  v_lshlrev_b32 v236, 16, v236
  v_pk_add_f32 v[220:221], v[220:221], v[236:237]
  v_cvt_pk_bf16_f32 v220, v220, v221
  v_and_b32 v221, s12, v220
  v_lshlrev_b32 v220, 16, v220
  v_pk_mul_f32 v[238:239], v[238:239], v[44:45]
  v_cvt_pk_bf16_f32 v238, v238, v239
  v_and_b32 v239, s12, v238
  v_lshlrev_b32 v238, 16, v238
  v_pk_add_f32 v[222:223], v[222:223], v[238:239]
  v_cvt_pk_bf16_f32 v222, v222, v223
  v_and_b32 v223, s12, v222
  v_lshlrev_b32 v222, 16, v222
  v_pk_mul_f32 v[240:241], v[240:241], v[46:47]
  v_cvt_pk_bf16_f32 v240, v240, v241
  v_and_b32 v241, s12, v240
  v_lshlrev_b32 v240, 16, v240
  v_pk_add_f32 v[224:225], v[224:225], v[240:241]
  v_cvt_pk_bf16_f32 v224, v224, v225
  v_and_b32 v225, s12, v224
  v_lshlrev_b32 v224, 16, v224
  v_cvt_pk_bf16_f32 v56, v210, v211
  v_cvt_pk_bf16_f32 v57, v212, v213
  v_cvt_pk_bf16_f32 v58, v214, v215
  v_cvt_pk_bf16_f32 v59, v216, v217
  v_cvt_pk_bf16_f32 v60, v218, v219
  v_cvt_pk_bf16_f32 v61, v220, v221
  v_cvt_pk_bf16_f32 v62, v222, v223
  v_cvt_pk_bf16_f32 v63, v224, v225
  s_mov_b32 s6, 12582912
  s_cmp_lg_u32 s67, 0
  s_cbranch_scc1 L_fast_129
  buffer_store_dwordx4 v[56:59], v200, s[40:43], s6 offen offset:0 sc1
  buffer_store_dwordx4 v[60:63], v200, s[40:43], s6 offen offset:896 sc1
  s_branch L_sdone_130
L_fast_129:
  buffer_store_dwordx4 v[56:59], v200, s[40:43], s6 offen offset:0
  buffer_store_dwordx4 v[60:63], v200, s[40:43], s6 offen offset:896
L_sdone_130:
  s_nop 0
  v_readfirstlane_b32 s56, v210
  v_readfirstlane_b32 s57, v210
  v_readfirstlane_b32 s58, v218
  v_readfirstlane_b32 s59, v218
  s_mov_b32 s64, 0x3b124925
  v_pk_add_f32 v[226:227], v[210:211], s[56:57] neg_lo:[0,1] neg_hi:[0,1]
  v_pk_add_f32 v[228:229], v[212:213], s[56:57] neg_lo:[0,1] neg_hi:[0,1]
  v_pk_add_f32 v[230:231], v[214:215], s[56:57] neg_lo:[0,1] neg_hi:[0,1]
  v_pk_add_f32 v[232:233], v[216:217], s[56:57] neg_lo:[0,1] neg_hi:[0,1]
  v_pk_add_f32 v[234:235], v[218:219], s[58:59] neg_lo:[0,1] neg_hi:[0,1]
  v_pk_add_f32 v[236:237], v[220:221], s[58:59] neg_lo:[0,1] neg_hi:[0,1]
  v_pk_add_f32 v[238:239], v[222:223], s[58:59] neg_lo:[0,1] neg_hi:[0,1]
  v_pk_add_f32 v[240:241], v[224:225], s[58:59] neg_lo:[0,1] neg_hi:[0,1]
  v_pk_add_f32 v[20:21], v[226:227], v[228:229]
  v_pk_mul_f32 v[22:23], v[226:227], v[226:227]
  v_pk_add_f32 v[20:21], v[20:21], v[230:231]
  v_pk_add_f32 v[20:21], v[20:21], v[232:233]
  v_pk_fma_f32 v[22:23], v[228:229], v[228:229], v[22:23]
  v_pk_fma_f32 v[22:23], v[230:231], v[230:231], v[22:23]
  v_pk_fma_f32 v[22:23], v[232:233], v[232:233], v[22:23]
  v_pk_add_f32 v[24:25], v[234:235], v[236:237]
  v_pk_mul_f32 v[26:27], v[234:235], v[234:235]
  v_pk_add_f32 v[24:25], v[24:25], v[238:239]
  v_pk_add_f32 v[24:25], v[24:25], v[240:241]
  v_pk_fma_f32 v[26:27], v[236:237], v[236:237], v[26:27]
  v_pk_fma_f32 v[26:27], v[238:239], v[238:239], v[26:27]
  v_pk_fma_f32 v[26:27], v[240:241], v[240:241], v[26:27]
  v_add_f32 v20, v20, v21
  v_add_f32 v21, v22, v23
  v_add_f32 v24, v24, v25
  v_add_f32 v25, v26, v27
  v_mul_f32 v20, v201, v20
  v_mul_f32 v21, v201, v21
  v_mul_f32 v24, v201, v24
  v_mul_f32 v25, v201, v25
  v_add_f32_dpp v20, v20, v20 quad_perm:[1,0,3,2] row_mask:0xf bank_mask:0xf
  v_add_f32_dpp v21, v21, v21 quad_perm:[1,0,3,2] row_mask:0xf bank_mask:0xf
  v_add_f32_dpp v24, v24, v24 quad_perm:[1,0,3,2] row_mask:0xf bank_mask:0xf
  v_add_f32_dpp v25, v25, v25 quad_perm:[1,0,3,2] row_mask:0xf bank_mask:0xf
  v_add_f32_dpp v20, v20, v20 quad_perm:[2,3,0,1] row_mask:0xf bank_mask:0xf
  v_add_f32_dpp v21, v21, v21 quad_perm:[2,3,0,1] row_mask:0xf bank_mask:0xf
  v_add_f32_dpp v24, v24, v24 quad_perm:[2,3,0,1] row_mask:0xf bank_mask:0xf
  v_add_f32_dpp v25, v25, v25 quad_perm:[2,3,0,1] row_mask:0xf bank_mask:0xf
  v_add_f32_dpp v20, v20, v20 row_half_mirror row_mask:0xf bank_mask:0xf
  v_add_f32_dpp v21, v21, v21 row_half_mirror row_mask:0xf bank_mask:0xf
  v_add_f32_dpp v24, v24, v24 row_half_mirror row_mask:0xf bank_mask:0xf
  v_add_f32_dpp v25, v25, v25 row_half_mirror row_mask:0xf bank_mask:0xf
  v_add_f32_dpp v20, v20, v20 row_mirror row_mask:0xf bank_mask:0xf
  v_add_f32_dpp v21, v21, v21 row_mirror row_mask:0xf bank_mask:0xf
  v_add_f32_dpp v24, v24, v24 row_mirror row_mask:0xf bank_mask:0xf
  v_add_f32_dpp v25, v25, v25 row_mirror row_mask:0xf bank_mask:0xf
  v_add_f32_dpp v20, v20, v20 row_bcast:15 row_mask:0xa bank_mask:0xf
  v_add_f32_dpp v21, v21, v21 row_bcast:15 row_mask:0xa bank_mask:0xf
  v_add_f32_dpp v24, v24, v24 row_bcast:15 row_mask:0xa bank_mask:0xf
  v_add_f32_dpp v25, v25, v25 row_bcast:15 row_mask:0xa bank_mask:0xf
  v_add_f32_dpp v20, v20, v20 row_bcast:31 row_mask:0xc bank_mask:0xf
  v_add_f32_dpp v21, v21, v21 row_bcast:31 row_mask:0xc bank_mask:0xf
  v_add_f32_dpp v24, v24, v24 row_bcast:31 row_mask:0xc bank_mask:0xf
  v_add_f32_dpp v25, v25, v25 row_bcast:31 row_mask:0xc bank_mask:0xf
  v_readlane_b32 s60, v20, 63
  v_readlane_b32 s61, v21, 63
  v_readlane_b32 s62, v24, 63
  v_readlane_b32 s63, v25, 63
  v_mov_b32 v28, s64
  v_mul_f32 v20, s60, v28
  v_mul_f32 v21, s62, v28
  v_mul_f32 v22, s61, v28
  v_mul_f32 v23, s63, v28
  v_pk_fma_f32 v[22:23], v[20:21], v[20:21], v[22:23] neg_lo:[1,0,0] neg_hi:[1,0,0]
  v_add_f32 v20, s56, v20
  v_add_f32 v21, s58, v21
  v_max_f32 v22, 0, v22
  v_max_f32 v23, 0, v23
  v_cvt_pk_bf16_f32 v20, v20, v21
  v_and_b32 v21, s12, v20
  v_lshlrev_b32 v20, 16, v20
  v_cvt_pk_bf16_f32 v22, v22, v23
  v_and_b32 v23, s12, v22
  v_lshlrev_b32 v22, 16, v22
  v_add_f32 v22, 0x3727c5ac, v22
  v_add_f32 v23, 0x3727c5ac, v23
  v_cvt_pk_bf16_f32 v22, v22, v23
  v_and_b32 v23, s12, v22
  v_lshlrev_b32 v22, 16, v22
  v_sqrt_f32 v22, v22
  v_sqrt_f32 v23, v23
  v_pk_add_f32 v[226:227], v[210:211], v[20:21] op_sel_hi:[1,0] neg_lo:[0,1] neg_hi:[0,1]
  v_pk_add_f32 v[228:229], v[212:213], v[20:21] op_sel_hi:[1,0] neg_lo:[0,1] neg_hi:[0,1]
  v_pk_add_f32 v[230:231], v[214:215], v[20:21] op_sel_hi:[1,0] neg_lo:[0,1] neg_hi:[0,1]
  v_pk_add_f32 v[232:233], v[216:217], v[20:21] op_sel_hi:[1,0] neg_lo:[0,1] neg_hi:[0,1]
  v_cvt_pk_bf16_f32 v22, v22, v23
  v_and_b32 v23, s12, v22
  v_lshlrev_b32 v22, 16, v22
  v_rcp_f32 v24, v22
  v_rcp_f32 v25, v23
  v_pk_add_f32 v[234:235], v[218:219], v[20:21] op_sel:[0,1] op_sel_hi:[1,1] neg_lo:[0,1] neg_hi:[0,1]
  v_pk_add_f32 v[236:237], v[220:221], v[20:21] op_sel:[0,1] op_sel_hi:[1,1] neg_lo:[0,1] neg_hi:[0,1]
  v_pk_add_f32 v[238:239], v[222:223], v[20:21] op_sel:[0,1] op_sel_hi:[1,1] neg_lo:[0,1] neg_hi:[0,1]
  v_pk_add_f32 v[240:241], v[224:225], v[20:21] op_sel:[0,1] op_sel_hi:[1,1] neg_lo:[0,1] neg_hi:[0,1]
  v_fma_f32 v26, -v22, v24, 1.0
  v_fma_f32 v27, -v23, v25, 1.0
  v_pk_fma_f32 v[24:25], v[26:27], v[24:25], v[24:25]
  v_cvt_pk_bf16_f32 v226, v226, v227
  v_and_b32 v227, s12, v226
  v_lshlrev_b32 v226, 16, v226
  v_pk_mul_f32 v[226:227], v[226:227], v[24:25] op_sel_hi:[1,0]
  v_cvt_pk_bf16_f32 v48, v226, v227
  v_cvt_pk_bf16_f32 v228, v228, v229
  v_and_b32 v229, s12, v228
  v_lshlrev_b32 v228, 16, v228
  v_pk_mul_f32 v[228:229], v[228:229], v[24:25] op_sel_hi:[1,0]
  v_cvt_pk_bf16_f32 v49, v228, v229
  v_cvt_pk_bf16_f32 v230, v230, v231
  v_and_b32 v231, s12, v230
  v_lshlrev_b32 v230, 16, v230
  v_pk_mul_f32 v[230:231], v[230:231], v[24:25] op_sel_hi:[1,0]
  v_cvt_pk_bf16_f32 v50, v230, v231
  v_cvt_pk_bf16_f32 v232, v232, v233
  v_and_b32 v233, s12, v232
  v_lshlrev_b32 v232, 16, v232
  v_pk_mul_f32 v[232:233], v[232:233], v[24:25] op_sel_hi:[1,0]
  v_cvt_pk_bf16_f32 v51, v232, v233
  v_cvt_pk_bf16_f32 v234, v234, v235
  v_and_b32 v235, s12, v234
  v_lshlrev_b32 v234, 16, v234
  v_pk_mul_f32 v[234:235], v[234:235], v[24:25] op_sel:[0,1] op_sel_hi:[1,1]
  v_cvt_pk_bf16_f32 v52, v234, v235
  v_cvt_pk_bf16_f32 v236, v236, v237
  v_and_b32 v237, s12, v236
  v_lshlrev_b32 v236, 16, v236
  v_pk_mul_f32 v[236:237], v[236:237], v[24:25] op_sel:[0,1] op_sel_hi:[1,1]
  v_cvt_pk_bf16_f32 v53, v236, v237
  v_cvt_pk_bf16_f32 v238, v238, v239
  v_and_b32 v239, s12, v238
  v_lshlrev_b32 v238, 16, v238
  v_pk_mul_f32 v[238:239], v[238:239], v[24:25] op_sel:[0,1] op_sel_hi:[1,1]
  v_cvt_pk_bf16_f32 v54, v238, v239
  v_cvt_pk_bf16_f32 v240, v240, v241
  v_and_b32 v241, s12, v240
  v_lshlrev_b32 v240, 16, v240
  v_pk_mul_f32 v[240:241], v[240:241], v[24:25] op_sel:[0,1] op_sel_hi:[1,1]
  v_cvt_pk_bf16_f32 v55, v240, v241
  s_mov_b32 s6, 6291456
  s_cmp_lg_u32 s67, 0
  s_cbranch_scc1 L_fast_131
  buffer_store_dwordx4 v[48:51], v247, s[40:43], s6 offen offset:0 sc1
  buffer_store_dwordx4 v[52:55], v247, s[40:43], s6 offen offset:16 sc1
  s_branch L_sdone_132
L_fast_131:
  buffer_store_dwordx4 v[48:51], v247, s[40:43], s6 offen offset:0
  buffer_store_dwordx4 v[52:55], v247, s[40:43], s6 offen offset:16
L_sdone_132:
  s_add_u32 s71, s71, 16384
  s_mov_b32 s95, 1
  s_add_u32 s76, s71, 0
  s_waitcnt vmcnt(0)
  s_cmp_lg_u32 s67, 0
  s_cbranch_scc1 L_fast_133
  buffer_store_dword v245, v246, s[40:43], s76 offen sc1
  s_branch L_sdone_134
L_fast_133:
  buffer_store_dword v245, v246, s[40:43], s76 offen
L_sdone_134:
  v_and_b32 v242, 15, v0
  v_lshl_add_u32 v242, s3, 4, v242
  v_lshlrev_b32 v242, 2, v242
  s_add_u32 s76, s71, 0
  s_mov_b32 s77, 0
L_poll_135:
  buffer_load_dword v243, v242, s[40:43], s76 offen sc1
  s_add_u32 s77, s77, 1
  s_waitcnt vmcnt(0)
  v_cmp_ne_u32 vcc, s70, v243
  s_cmp_ge_u32 s77, 400000
  s_cbranch_scc1 L_pdone_136
  s_cbranch_vccnz L_poll_135
L_pdone_136:
  s_mov_b32 s65, 0
  s_mul_i32 s15, s95, 0
  s_add_u32 s15, s15, 16777216
  s_mul_i32 s11, s95, 0
  s_add_u32 s11, s11, 6291456
  s_lshl_b32 s6, s4, 7
  s_lshl_b32 s7, s3, 5
  s_add_u32 s6, s6, s7
  s_mul_i32 s6, s6, 896
  s_add_u32 s6, s6, s11
  s_add_u32 s7, s6, 14336
  v_lshlrev_b32 v3, 4, v0
  v_add_u32 v2, 0x1000, v3
  v_add_u32 v1, 0x2000, v3
  v_add_u32 v9, 0x3000, v3
  buffer_load_dwordx4 v[16:19], v3, s[40:43], s6 offen offset:0 sc1
  buffer_load_dwordx4 v[72:75], v3, s[40:43], s7 offen offset:0 sc1
  buffer_load_dwordx4 v[20:23], v3, s[40:43], s6 offen offset:1024 sc1
  buffer_load_dwordx4 v[76:79], v3, s[40:43], s7 offen offset:1024 sc1
  buffer_load_dwordx4 v[24:27], v3, s[40:43], s6 offen offset:2048 sc1
  buffer_load_dwordx4 v[80:83], v3, s[40:43], s7 offen offset:2048 sc1
  buffer_load_dwordx4 v[28:31], v3, s[40:43], s6 offen offset:3072 sc1
  buffer_load_dwordx4 v[84:87], v3, s[40:43], s7 offen offset:3072 sc1
  buffer_load_dwordx4 v[32:35], v2, s[40:43], s6 offen offset:0 sc1
  buffer_load_dwordx4 v[88:91], v2, s[40:43], s7 offen offset:0 sc1
  v_lshlrev_b32 v4, 4, v0
  v_add_u32 v5, 0x10000, v4
  v_add_u32 v6, 114688, v4
  s_lshl_b32 s88, s4, 2
  s_add_u32 s88, s88, s3
  s_mul_i32 s88, s88, 112
  s_mul_i32 s8, s5, 7
  s_add_u32 s88, s88, s8
  s_lshl_b32 s88, s88, 10
  s_add_u32 s88, s88, s15
  s_add_u32 s89, s88, 4096
  s_cmp_ge_u32 s5, 7
  s_cselect_b32 s8, 1, 0
  s_mul_i32 s9, s8, 7
  s_sub_u32 s9, s5, s9
  s_lshl_b32 s13, s4, 2
  s_lshl_b32 s8, s8, 1
  s_add_u32 s13, s13, s8
  s_mul_i32 s90, s13, 112
  s_mul_i32 s8, s3, 28
  s_add_u32 s90, s90, s8
  s_lshl_b32 s90, s90, 10
  s_add_u32 s90, s90, s15
  s_mul_i32 s91, s9, 112
  s_add_u32 s91, s91, s8
  s_lshl_b32 s91, s91, 11
  s_add_u32 s91, s91, 35651584
  s_mov_b32 s14, s9
  ds_read_b128 v[168:171], v4 offset:0
  ds_read_b128 v[172:175], v4 offset:14336
  ds_read_b128 v[176:179], v4 offset:28672
  ds_read_b128 v[180:183], v4 offset:43008
  ds_read_b128 v[184:187], v4 offset:1024
  ds_read_b128 v[188:191], v4 offset:15360
  ds_read_b128 v[192:195], v4 offset:29696
  ds_read_b128 v[196:199], v4 offset:44032
  ds_read_b128 v[226:229], v4 offset:2048
  ds_read_b128 v[230:233], v4 offset:16384
  ds_read_b128 v[234:237], v4 offset:30720
  ds_read_b128 v[238:241], v4 offset:45056
  buffer_load_dwordx4 v[36:39], v2, s[40:43], s6 offen offset:1024 sc1
  buffer_load_dwordx4 v[92:95], v2, s[40:43], s7 offen offset:1024 sc1
  s_waitcnt vmcnt(10)
  s_waitcnt lgkmcnt(8)
  v_mfma_f32_16x16x32_bf16 v[128:131], v[168:171], v[16:19], 0
  v_mfma_f32_16x16x32_bf16 v[132:135], v[168:171], v[72:75], 0
  v_mfma_f32_16x16x32_bf16 v[136:139], v[172:175], v[16:19], 0
  v_mfma_f32_16x16x32_bf16 v[140:143], v[172:175], v[72:75], 0
  v_mfma_f32_16x16x32_bf16 v[144:147], v[176:179], v[16:19], 0
  v_mfma_f32_16x16x32_bf16 v[148:151], v[176:179], v[72:75], 0
  v_mfma_f32_16x16x32_bf16 v[152:155], v[180:183], v[16:19], 0
  v_mfma_f32_16x16x32_bf16 v[156:159], v[180:183], v[72:75], 0
  ds_read_b128 v[168:171], v4 offset:3072
  ds_read_b128 v[172:175], v4 offset:17408
  ds_read_b128 v[176:179], v4 offset:31744
  ds_read_b128 v[180:183], v4 offset:46080
  buffer_load_dwordx4 v[40:43], v2, s[40:43], s6 offen offset:2048 sc1
  buffer_load_dwordx4 v[96:99], v2, s[40:43], s7 offen offset:2048 sc1
  s_waitcnt vmcnt(10)
  s_waitcnt lgkmcnt(8)
  v_mfma_f32_16x16x32_bf16 v[128:131], v[184:187], v[20:23], v[128:131]
  v_mfma_f32_16x16x32_bf16 v[132:135], v[184:187], v[76:79], v[132:135]
  v_mfma_f32_16x16x32_bf16 v[136:139], v[188:191], v[20:23], v[136:139]
  v_mfma_f32_16x16x32_bf16 v[140:143], v[188:191], v[76:79], v[140:143]
  v_mfma_f32_16x16x32_bf16 v[144:147], v[192:195], v[20:23], v[144:147]
  v_mfma_f32_16x16x32_bf16 v[148:151], v[192:195], v[76:79], v[148:151]
  v_mfma_f32_16x16x32_bf16 v[152:155], v[196:199], v[20:23], v[152:155]
  v_mfma_f32_16x16x32_bf16 v[156:159], v[196:199], v[76:79], v[156:159]
  ds_read_b128 v[184:187], v4 offset:4096
  ds_read_b128 v[188:191], v4 offset:18432
  ds_read_b128 v[192:195], v4 offset:32768
  ds_read_b128 v[196:199], v4 offset:47104
  buffer_load_dwordx4 v[44:47], v2, s[40:43], s6 offen offset:3072 sc1
  buffer_load_dwordx4 v[100:103], v2, s[40:43], s7 offen offset:3072 sc1
  s_waitcnt vmcnt(10)
  s_waitcnt lgkmcnt(8)
  v_mfma_f32_16x16x32_bf16 v[128:131], v[226:229], v[24:27], v[128:131]
  v_mfma_f32_16x16x32_bf16 v[132:135], v[226:229], v[80:83], v[132:135]
  v_mfma_f32_16x16x32_bf16 v[136:139], v[230:233], v[24:27], v[136:139]
  v_mfma_f32_16x16x32_bf16 v[140:143], v[230:233], v[80:83], v[140:143]
  v_mfma_f32_16x16x32_bf16 v[144:147], v[234:237], v[24:27], v[144:147]
  v_mfma_f32_16x16x32_bf16 v[148:151], v[234:237], v[80:83], v[148:151]
  v_mfma_f32_16x16x32_bf16 v[152:155], v[238:241], v[24:27], v[152:155]
  v_mfma_f32_16x16x32_bf16 v[156:159], v[238:241], v[80:83], v[156:159]
  ds_read_b128 v[226:229], v4 offset:5120
  ds_read_b128 v[230:233], v4 offset:19456
  ds_read_b128 v[234:237], v4 offset:33792
  ds_read_b128 v[238:241], v4 offset:48128
  buffer_load_dwordx4 v[48:51], v1, s[40:43], s6 offen offset:0 sc1
  buffer_load_dwordx4 v[104:107], v1, s[40:43], s7 offen offset:0 sc1
  s_waitcnt vmcnt(10)
  s_waitcnt lgkmcnt(8)
  v_mfma_f32_16x16x32_bf16 v[128:131], v[168:171], v[28:31], v[128:131]
  v_mfma_f32_16x16x32_bf16 v[132:135], v[168:171], v[84:87], v[132:135]
  v_mfma_f32_16x16x32_bf16 v[136:139], v[172:175], v[28:31], v[136:139]
  v_mfma_f32_16x16x32_bf16 v[140:143], v[172:175], v[84:87], v[140:143]
  v_mfma_f32_16x16x32_bf16 v[144:147], v[176:179], v[28:31], v[144:147]
  v_mfma_f32_16x16x32_bf16 v[148:151], v[176:179], v[84:87], v[148:151]
  v_mfma_f32_16x16x32_bf16 v[152:155], v[180:183], v[28:31], v[152:155]
  v_mfma_f32_16x16x32_bf16 v[156:159], v[180:183], v[84:87], v[156:159]
  ds_read_b128 v[168:171], v4 offset:6144
  ds_read_b128 v[172:175], v4 offset:20480
  ds_read_b128 v[176:179], v4 offset:34816
  ds_read_b128 v[180:183], v4 offset:49152
  buffer_load_dwordx4 v[52:55], v1, s[40:43], s6 offen offset:1024 sc1
  buffer_load_dwordx4 v[108:111], v1, s[40:43], s7 offen offset:1024 sc1
  s_waitcnt vmcnt(10)
  s_waitcnt lgkmcnt(8)
  v_mfma_f32_16x16x32_bf16 v[128:131], v[184:187], v[32:35], v[128:131]
  v_mfma_f32_16x16x32_bf16 v[132:135], v[184:187], v[88:91], v[132:135]
  v_mfma_f32_16x16x32_bf16 v[136:139], v[188:191], v[32:35], v[136:139]
  v_mfma_f32_16x16x32_bf16 v[140:143], v[188:191], v[88:91], v[140:143]
  v_mfma_f32_16x16x32_bf16 v[144:147], v[192:195], v[32:35], v[144:147]
  v_mfma_f32_16x16x32_bf16 v[148:151], v[192:195], v[88:91], v[148:151]
  v_mfma_f32_16x16x32_bf16 v[152:155], v[196:199], v[32:35], v[152:155]
  v_mfma_f32_16x16x32_bf16 v[156:159], v[196:199], v[88:91], v[156:159]
  ds_read_b128 v[184:187], v4 offset:7168
  ds_read_b128 v[188:191], v4 offset:21504
  ds_read_b128 v[192:195], v4 offset:35840
  ds_read_b128 v[196:199], v4 offset:50176
  buffer_load_dwordx4 v[56:59], v1, s[40:43], s6 offen offset:2048 sc1
  buffer_load_dwordx4 v[112:115], v1, s[40:43], s7 offen offset:2048 sc1
  s_waitcnt vmcnt(10)
  s_waitcnt lgkmcnt(8)
  v_mfma_f32_16x16x32_bf16 v[128:131], v[226:229], v[36:39], v[128:131]
  v_mfma_f32_16x16x32_bf16 v[132:135], v[226:229], v[92:95], v[132:135]
  v_mfma_f32_16x16x32_bf16 v[136:139], v[230:233], v[36:39], v[136:139]
  v_mfma_f32_16x16x32_bf16 v[140:143], v[230:233], v[92:95], v[140:143]
  v_mfma_f32_16x16x32_bf16 v[144:147], v[234:237], v[36:39], v[144:147]
  v_mfma_f32_16x16x32_bf16 v[148:151], v[234:237], v[92:95], v[148:151]
  v_mfma_f32_16x16x32_bf16 v[152:155], v[238:241], v[36:39], v[152:155]
  v_mfma_f32_16x16x32_bf16 v[156:159], v[238:241], v[92:95], v[156:159]
  ds_read_b128 v[226:229], v4 offset:8192
  ds_read_b128 v[230:233], v4 offset:22528
  ds_read_b128 v[234:237], v4 offset:36864
  ds_read_b128 v[238:241], v4 offset:51200
  buffer_load_dwordx4 v[60:63], v1, s[40:43], s6 offen offset:3072 sc1
  buffer_load_dwordx4 v[116:119], v1, s[40:43], s7 offen offset:3072 sc1
  s_waitcnt vmcnt(10)
  s_waitcnt lgkmcnt(8)
  v_mfma_f32_16x16x32_bf16 v[128:131], v[168:171], v[40:43], v[128:131]
  v_mfma_f32_16x16x32_bf16 v[132:135], v[168:171], v[96:99], v[132:135]
  v_mfma_f32_16x16x32_bf16 v[136:139], v[172:175], v[40:43], v[136:139]
  v_mfma_f32_16x16x32_bf16 v[140:143], v[172:175], v[96:99], v[140:143]
  v_mfma_f32_16x16x32_bf16 v[144:147], v[176:179], v[40:43], v[144:147]
  v_mfma_f32_16x16x32_bf16 v[148:151], v[176:179], v[96:99], v[148:151]
  v_mfma_f32_16x16x32_bf16 v[152:155], v[180:183], v[40:43], v[152:155]
  v_mfma_f32_16x16x32_bf16 v[156:159], v[180:183], v[96:99], v[156:159]
  ds_read_b128 v[168:171], v4 offset:9216
  ds_read_b128 v[172:175], v4 offset:23552
  ds_read_b128 v[176:179], v4 offset:37888
  ds_read_b128 v[180:183], v4 offset:52224
  buffer_load_dwordx4 v[64:67], v9, s[40:43], s6 offen offset:0 sc1
  buffer_load_dwordx4 v[120:123], v9, s[40:43], s7 offen offset:0 sc1
  s_waitcnt vmcnt(10)
  s_waitcnt lgkmcnt(8)
  v_mfma_f32_16x16x32_bf16 v[128:131], v[184:187], v[44:47], v[128:131]
  v_mfma_f32_16x16x32_bf16 v[132:135], v[184:187], v[100:103], v[132:135]
  v_mfma_f32_16x16x32_bf16 v[136:139], v[188:191], v[44:47], v[136:139]
  v_mfma_f32_16x16x32_bf16 v[140:143], v[188:191], v[100:103], v[140:143]
  v_mfma_f32_16x16x32_bf16 v[144:147], v[192:195], v[44:47], v[144:147]
  v_mfma_f32_16x16x32_bf16 v[148:151], v[192:195], v[100:103], v[148:151]
  v_mfma_f32_16x16x32_bf16 v[152:155], v[196:199], v[44:47], v[152:155]
  v_mfma_f32_16x16x32_bf16 v[156:159], v[196:199], v[100:103], v[156:159]
  ds_read_b128 v[184:187], v4 offset:10240
  ds_read_b128 v[188:191], v4 offset:24576
  ds_read_b128 v[192:195], v4 offset:38912
  ds_read_b128 v[196:199], v4 offset:53248
  buffer_load_dwordx4 v[68:71], v9, s[40:43], s6 offen offset:1024 sc1
  buffer_load_dwordx4 v[124:127], v9, s[40:43], s7 offen offset:1024 sc1
  s_waitcnt vmcnt(10)
  s_waitcnt lgkmcnt(8)
  v_mfma_f32_16x16x32_bf16 v[128:131], v[226:229], v[48:51], v[128:131]
  v_mfma_f32_16x16x32_bf16 v[132:135], v[226:229], v[104:107], v[132:135]
  v_mfma_f32_16x16x32_bf16 v[136:139], v[230:233], v[48:51], v[136:139]
  v_mfma_f32_16x16x32_bf16 v[140:143], v[230:233], v[104:107], v[140:143]
  v_mfma_f32_16x16x32_bf16 v[144:147], v[234:237], v[48:51], v[144:147]
  v_mfma_f32_16x16x32_bf16 v[148:151], v[234:237], v[104:107], v[148:151]
  v_mfma_f32_16x16x32_bf16 v[152:155], v[238:241], v[48:51], v[152:155]
  v_mfma_f32_16x16x32_bf16 v[156:159], v[238:241], v[104:107], v[156:159]
  ds_read_b128 v[226:229], v4 offset:11264
  ds_read_b128 v[230:233], v4 offset:25600
  ds_read_b128 v[234:237], v4 offset:39936
  ds_read_b128 v[238:241], v4 offset:54272
  s_waitcnt vmcnt(8)
  s_waitcnt lgkmcnt(8)
  v_mfma_f32_16x16x32_bf16 v[128:131], v[168:171], v[52:55], v[128:131]
  v_mfma_f32_16x16x32_bf16 v[132:135], v[168:171], v[108:111], v[132:135]
  v_mfma_f32_16x16x32_bf16 v[136:139], v[172:175], v[52:55], v[136:139]
  v_mfma_f32_16x16x32_bf16 v[140:143], v[172:175], v[108:111], v[140:143]
  v_mfma_f32_16x16x32_bf16 v[144:147], v[176:179], v[52:55], v[144:147]
  v_mfma_f32_16x16x32_bf16 v[148:151], v[176:179], v[108:111], v[148:151]
  v_mfma_f32_16x16x32_bf16 v[152:155], v[180:183], v[52:55], v[152:155]
  v_mfma_f32_16x16x32_bf16 v[156:159], v[180:183], v[108:111], v[156:159]
  ds_read_b128 v[168:171], v4 offset:12288
  ds_read_b128 v[172:175], v4 offset:26624
  ds_read_b128 v[176:179], v4 offset:40960
  ds_read_b128 v[180:183], v4 offset:55296
  s_waitcnt vmcnt(6)
  s_waitcnt lgkmcnt(8)
  v_mfma_f32_16x16x32_bf16 v[128:131], v[184:187], v[56:59], v[128:131]
  v_mfma_f32_16x16x32_bf16 v[132:135], v[184:187], v[112:115], v[132:135]
  v_mfma_f32_16x16x32_bf16 v[136:139], v[188:191], v[56:59], v[136:139]
  v_mfma_f32_16x16x32_bf16 v[140:143], v[188:191], v[112:115], v[140:143]
  v_mfma_f32_16x16x32_bf16 v[144:147], v[192:195], v[56:59], v[144:147]
  v_mfma_f32_16x16x32_bf16 v[148:151], v[192:195], v[112:115], v[148:151]
  v_mfma_f32_16x16x32_bf16 v[152:155], v[196:199], v[56:59], v[152:155]
  v_mfma_f32_16x16x32_bf16 v[156:159], v[196:199], v[112:115], v[156:159]
  ds_read_b128 v[184:187], v4 offset:13312
  ds_read_b128 v[188:191], v4 offset:27648
  ds_read_b128 v[192:195], v4 offset:41984
  ds_read_b128 v[196:199], v4 offset:56320
  s_waitcnt vmcnt(4)
  s_waitcnt lgkmcnt(8)
  v_mfma_f32_16x16x32_bf16 v[128:131], v[226:229], v[60:63], v[128:131]
  v_mfma_f32_16x16x32_bf16 v[132:135], v[226:229], v[116:119], v[132:135]
  v_mfma_f32_16x16x32_bf16 v[136:139], v[230:233], v[60:63], v[136:139]
  v_mfma_f32_16x16x32_bf16 v[140:143], v[230:233], v[116:119], v[140:143]
  v_mfma_f32_16x16x32_bf16 v[144:147], v[234:237], v[60:63], v[144:147]
  v_mfma_f32_16x16x32_bf16 v[148:151], v[234:237], v[116:119], v[148:151]
  v_mfma_f32_16x16x32_bf16 v[152:155], v[238:241], v[60:63], v[152:155]
  v_mfma_f32_16x16x32_bf16 v[156:159], v[238:241], v[116:119], v[156:159]
  s_waitcnt vmcnt(2)
  s_waitcnt lgkmcnt(4)
  v_mfma_f32_16x16x32_bf16 v[128:131], v[168:171], v[64:67], v[128:131]
  v_mfma_f32_16x16x32_bf16 v[132:135], v[168:171], v[120:123], v[132:135]
  v_mfma_f32_16x16x32_bf16 v[136:139], v[172:175], v[64:67], v[136:139]
  v_mfma_f32_16x16x32_bf16 v[140:143], v[172:175], v[120:123], v[140:143]
  v_mfma_f32_16x16x32_bf16 v[144:147], v[176:179], v[64:67], v[144:147]
  v_mfma_f32_16x16x32_bf16 v[148:151], v[176:179], v[120:123], v[148:151]
  v_mfma_f32_16x16x32_bf16 v[152:155], v[180:183], v[64:67], v[152:155]
  v_mfma_f32_16x16x32_bf16 v[156:159], v[180:183], v[120:123], v[156:159]
  s_waitcnt vmcnt(0)
  s_waitcnt lgkmcnt(0)
  v_mfma_f32_16x16x32_bf16 v[128:131], v[184:187], v[68:71], v[128:131]
  v_mfma_f32_16x16x32_bf16 v[132:135], v[184:187], v[124:127], v[132:135]
  v_mfma_f32_16x16x32_bf16 v[136:139], v[188:191], v[68:71], v[136:139]
  v_mfma_f32_16x16x32_bf16 v[140:143], v[188:191], v[124:127], v[140:143]
  v_mfma_f32_16x16x32_bf16 v[144:147], v[192:195], v[68:71], v[144:147]
  v_mfma_f32_16x16x32_bf16 v[148:151], v[192:195], v[124:127], v[148:151]
  v_mfma_f32_16x16x32_bf16 v[152:155], v[196:199], v[68:71], v[152:155]
  v_mfma_f32_16x16x32_bf16 v[156:159], v[196:199], v[124:127], v[156:159]
  s_nop 7
  v_maximum3_f32 v128, v128, 0, 0
  v_maximum3_f32 v129, v129, 0, 0
  v_maximum3_f32 v130, v130, 0, 0
  v_maximum3_f32 v131, v131, 0, 0
  v_maximum3_f32 v132, v132, 0, 0
  v_maximum3_f32 v133, v133, 0, 0
  v_maximum3_f32 v134, v134, 0, 0
  v_maximum3_f32 v135, v135, 0, 0
  v_cvt_pk_bf16_f32 v128, v128, v129
  v_cvt_pk_bf16_f32 v129, v130, v131
  v_cvt_pk_bf16_f32 v130, v132, v133
  v_cvt_pk_bf16_f32 v131, v134, v135
  v_maximum3_f32 v136, v136, 0, 0
  v_maximum3_f32 v137, v137, 0, 0
  v_maximum3_f32 v138, v138, 0, 0
  v_maximum3_f32 v139, v139, 0, 0
  v_maximum3_f32 v140, v140, 0, 0
  v_maximum3_f32 v141, v141, 0, 0
  v_maximum3_f32 v142, v142, 0, 0
  v_maximum3_f32 v143, v143, 0, 0
  v_cvt_pk_bf16_f32 v136, v136, v137
  v_cvt_pk_bf16_f32 v137, v138, v139
  v_cvt_pk_bf16_f32 v138, v140, v141
  v_cvt_pk_bf16_f32 v139, v142, v143
  v_maximum3_f32 v144, v144, 0, 0
  v_maximum3_f32 v145, v145, 0, 0
  v_maximum3_f32 v146, v146, 0, 0
  v_maximum3_f32 v147, v147, 0, 0
  v_maximum3_f32 v148, v148, 0, 0
  v_maximum3_f32 v149, v149, 0, 0
  v_maximum3_f32 v150, v150, 0, 0
  v_maximum3_f32 v151, v151, 0, 0
  v_cvt_pk_bf16_f32 v144, v144, v145
  v_cvt_pk_bf16_f32 v145, v146, v147
  v_cvt_pk_bf16_f32 v146, v148, v149
  v_cvt_pk_bf16_f32 v147, v150, v151
  v_maximum3_f32 v152, v152, 0, 0
  v_maximum3_f32 v153, v153, 0, 0
  v_maximum3_f32 v154, v154, 0, 0
  v_maximum3_f32 v155, v155, 0, 0
  v_maximum3_f32 v156, v156, 0, 0
  v_maximum3_f32 v157, v157, 0, 0
  v_maximum3_f32 v158, v158, 0, 0
  v_maximum3_f32 v159, v159, 0, 0
  v_cvt_pk_bf16_f32 v152, v152, v153
  v_cvt_pk_bf16_f32 v153, v154, v155
  v_cvt_pk_bf16_f32 v154, v156, v157
  v_cvt_pk_bf16_f32 v155, v158, v159
  s_nop 1
  v_permlane16_swap_b32 v128, v130
  v_permlane16_swap_b32 v129, v131
  v_permlane16_swap_b32 v136, v138
  v_permlane16_swap_b32 v137, v139
  v_permlane16_swap_b32 v144, v146
  v_permlane16_swap_b32 v145, v147
  v_permlane16_swap_b32 v152, v154
  v_permlane16_swap_b32 v153, v155
  s_cmp_lg_u32 s65, 0
  s_cbranch_scc1 L_fast_138
  buffer_store_dwordx4 v[128:131], v4, s[40:43], s88 offen offset:0 sc1
  buffer_store_dwordx4 v[136:139], v4, s[40:43], s88 offen offset:1024 sc1
  buffer_store_dwordx4 v[144:147], v4, s[40:43], s88 offen offset:2048 sc1
  buffer_store_dwordx4 v[152:155], v4, s[40:43], s88 offen offset:3072 sc1
  s_branch L_sdone_139
L_fast_138:
  buffer_store_dwordx4 v[128:131], v4, s[40:43], s88 offen offset:0
  buffer_store_dwordx4 v[136:139], v4, s[40:43], s88 offen offset:1024
  buffer_store_dwordx4 v[144:147], v4, s[40:43], s88 offen offset:2048
  buffer_store_dwordx4 v[152:155], v4, s[40:43], s88 offen offset:3072
L_sdone_139:
  ds_read_b128 v[168:171], v4 offset:57344
  ds_read_b128 v[172:175], v5 offset:6144
  ds_read_b128 v[176:179], v5 offset:20480
  ds_read_b128 v[184:187], v4 offset:58368
  ds_read_b128 v[188:191], v5 offset:7168
  ds_read_b128 v[192:195], v5 offset:21504
  ds_read_b128 v[226:229], v4 offset:59392
  ds_read_b128 v[230:233], v5 offset:8192
  ds_read_b128 v[234:237], v5 offset:22528
  s_waitcnt lgkmcnt(6)
  v_mfma_f32_16x16x32_bf16 v[128:131], v[168:171], v[16:19], 0
  v_mfma_f32_16x16x32_bf16 v[132:135], v[168:171], v[72:75], 0
  v_mfma_f32_16x16x32_bf16 v[136:139], v[172:175], v[16:19], 0
  v_mfma_f32_16x16x32_bf16 v[140:143], v[172:175], v[72:75], 0
  v_mfma_f32_16x16x32_bf16 v[144:147], v[176:179], v[16:19], 0
  v_mfma_f32_16x16x32_bf16 v[148:151], v[176:179], v[72:75], 0
  ds_read_b128 v[168:171], v4 offset:60416
  ds_read_b128 v[172:175], v5 offset:9216
  ds_read_b128 v[176:179], v5 offset:23552
  s_waitcnt lgkmcnt(6)
  v_mfma_f32_16x16x32_bf16 v[128:131], v[184:187], v[20:23], v[128:131]
  v_mfma_f32_16x16x32_bf16 v[132:135], v[184:187], v[76:79], v[132:135]
  v_mfma_f32_16x16x32_bf16 v[136:139], v[188:191], v[20:23], v[136:139]
  v_mfma_f32_16x16x32_bf16 v[140:143], v[188:191], v[76:79], v[140:143]
  v_mfma_f32_16x16x32_bf16 v[144:147], v[192:195], v[20:23], v[144:147]
  v_mfma_f32_16x16x32_bf16 v[148:151], v[192:195], v[76:79], v[148:151]
  ds_read_b128 v[184:187], v4 offset:61440
  ds_read_b128 v[188:191], v5 offset:10240
  ds_read_b128 v[192:195], v5 offset:24576
  s_waitcnt vmcnt(0)
  s_add_u32 s76, s71, 4096
  s_cmp_lg_u32 s67, 0
  s_cbranch_scc1 L_fast_140
  buffer_store_dword v245, v246, s[40:43], s76 offen sc1
  s_branch L_sdone_141
L_fast_140:
  buffer_store_dword v245, v246, s[40:43], s76 offen
L_sdone_141:
  s_cmp_ge_u32 s5, 7
  s_cselect_b32 s77, 2, 0
  v_bfe_u32 v242, v0, 1, 2
  v_lshl_add_u32 v242, s3, 2, v242
  v_lshl_add_u32 v242, v242, 2, s77
  v_and_b32 v243, 1, v0
  v_add_u32 v242, v242, v243
  v_lshlrev_b32 v242, 2, v242
  s_waitcnt lgkmcnt(6)
  v_mfma_f32_16x16x32_bf16 v[128:131], v[226:229], v[24:27], v[128:131]
  v_mfma_f32_16x16x32_bf16 v[132:135], v[226:229], v[80:83], v[132:135]
  v_mfma_f32_16x16x32_bf16 v[136:139], v[230:233], v[24:27], v[136:139]
  v_mfma_f32_16x16x32_bf16 v[140:143], v[230:233], v[80:83], v[140:143]
  v_mfma_f32_16x16x32_bf16 v[144:147], v[234:237], v[24:27], v[144:147]
  v_mfma_f32_16x16x32_bf16 v[148:151], v[234:237], v[80:83], v[148:151]
  ds_read_b128 v[226:229], v4 offset:62464
  ds_read_b128 v[230:233], v5 offset:11264
  ds_read_b128 v[234:237], v5 offset:25600
  s_waitcnt lgkmcnt(6)
  v_mfma_f32_16x16x32_bf16 v[128:131], v[168:171], v[28:31], v[128:131]
  v_mfma_f32_16x16x32_bf16 v[132:135], v[168:171], v[84:87], v[132:135]
  v_mfma_f32_16x16x32_bf16 v[136:139], v[172:175], v[28:31], v[136:139]
  v_mfma_f32_16x16x32_bf16 v[140:143], v[172:175], v[84:87], v[140:143]
  v_mfma_f32_16x16x32_bf16 v[144:147], v[176:179], v[28:31], v[144:147]
  v_mfma_f32_16x16x32_bf16 v[148:151], v[176:179], v[84:87], v[148:151]
  ds_read_b128 v[168:171], v4 offset:63488
  ds_read_b128 v[172:175], v5 offset:12288
  ds_read_b128 v[176:179], v5 offset:26624
  s_waitcnt lgkmcnt(6)
  v_mfma_f32_16x16x32_bf16 v[128:131], v[184:187], v[32:35], v[128:131]
  v_mfma_f32_16x16x32_bf16 v[132:135], v[184:187], v[88:91], v[132:135]
  v_mfma_f32_16x16x32_bf16 v[136:139], v[188:191], v[32:35], v[136:139]
  v_mfma_f32_16x16x32_bf16 v[140:143], v[188:191], v[88:91], v[140:143]
  v_mfma_f32_16x16x32_bf16 v[144:147], v[192:195], v[32:35], v[144:147]
  v_mfma_f32_16x16x32_bf16 v[148:151], v[192:195], v[88:91], v[148:151]
  ds_read_b128 v[184:187], v4 offset:64512
  ds_read_b128 v[188:191], v5 offset:13312
  ds_read_b128 v[192:195], v5 offset:27648
  s_waitcnt lgkmcnt(6)
  v_mfma_f32_16x16x32_bf16 v[128:131], v[226:229], v[36:39], v[128:131]
  v_mfma_f32_16x16x32_bf16 v[132:135], v[226:229], v[92:95], v[132:135]
  v_mfma_f32_16x16x32_bf16 v[136:139], v[230:233], v[36:39], v[136:139]
  v_mfma_f32_16x16x32_bf16 v[140:143], v[230:233], v[92:95], v[140:143]
  v_mfma_f32_16x16x32_bf16 v[144:147], v[234:237], v[36:39], v[144:147]
  v_mfma_f32_16x16x32_bf16 v[148:151], v[234:237], v[92:95], v[148:151]
  ds_read_b128 v[226:229], v5 offset:0
  ds_read_b128 v[230:233], v5 offset:14336
  ds_read_b128 v[234:237], v5 offset:28672
  buffer_load_dword v243, v242, s[40:43], s76 offen sc1
  s_waitcnt lgkmcnt(6)
  v_mfma_f32_16x16x32_bf16 v[128:131], v[168:171], v[40:43], v[128:131]
  v_mfma_f32_16x16x32_bf16 v[132:135], v[168:171], v[96:99], v[132:135]
  v_mfma_f32_16x16x32_bf16 v[136:139], v[172:175], v[40:43], v[136:139]
  v_mfma_f32_16x16x32_bf16 v[140:143], v[172:175], v[96:99], v[140:143]
  v_mfma_f32_16x16x32_bf16 v[144:147], v[176:179], v[40:43], v[144:147]
  v_mfma_f32_16x16x32_bf16 v[148:151], v[176:179], v[96:99], v[148:151]
  ds_read_b128 v[168:171], v5 offset:1024
  ds_read_b128 v[172:175], v5 offset:15360
  ds_read_b128 v[176:179], v5 offset:29696
  s_waitcnt lgkmcnt(6)
  v_mfma_f32_16x16x32_bf16 v[128:131], v[184:187], v[44:47], v[128:131]
  v_mfma_f32_16x16x32_bf16 v[132:135], v[184:187], v[100:103], v[132:135]
  v_mfma_f32_16x16x32_bf16 v[136:139], v[188:191], v[44:47], v[136:139]
  v_mfma_f32_16x16x32_bf16 v[140:143], v[188:191], v[100:103], v[140:143]
  v_mfma_f32_16x16x32_bf16 v[144:147], v[192:195], v[44:47], v[144:147]
  v_mfma_f32_16x16x32_bf16 v[148:151], v[192:195], v[100:103], v[148:151]
  ds_read_b128 v[184:187], v5 offset:2048
  ds_read_b128 v[188:191], v5 offset:16384
  ds_read_b128 v[192:195], v5 offset:30720
  s_waitcnt lgkmcnt(6)
  v_mfma_f32_16x16x32_bf16 v[128:131], v[226:229], v[48:51], v[128:131]
  v_mfma_f32_16x16x32_bf16 v[132:135], v[226:229], v[104:107], v[132:135]
  v_mfma_f32_16x16x32_bf16 v[136:139], v[230:233], v[48:51], v[136:139]
  v_mfma_f32_16x16x32_bf16 v[140:143], v[230:233], v[104:107], v[140:143]
  v_mfma_f32_16x16x32_bf16 v[144:147], v[234:237], v[48:51], v[144:147]
  v_mfma_f32_16x16x32_bf16 v[148:151], v[234:237], v[104:107], v[148:151]
  ds_read_b128 v[226:229], v5 offset:3072
  ds_read_b128 v[230:233], v5 offset:17408
  ds_read_b128 v[234:237], v5 offset:31744
  s_waitcnt lgkmcnt(6)
  v_mfma_f32_16x16x32_bf16 v[128:131], v[168:171], v[52:55], v[128:131]
  v_mfma_f32_16x16x32_bf16 v[132:135], v[168:171], v[108:111], v[132:135]
  v_mfma_f32_16x16x32_bf16 v[136:139], v[172:175], v[52:55], v[136:139]
  v_mfma_f32_16x16x32_bf16 v[140:143], v[172:175], v[108:111], v[140:143]
  v_mfma_f32_16x16x32_bf16 v[144:147], v[176:179], v[52:55], v[144:147]
  v_mfma_f32_16x16x32_bf16 v[148:151], v[176:179], v[108:111], v[148:151]
  ds_read_b128 v[168:171], v5 offset:4096
  ds_read_b128 v[172:175], v5 offset:18432
  ds_read_b128 v[176:179], v5 offset:32768
  s_cmp_ge_u32 s5, 14
  s_cbranch_scc1 L_pc_142
  s_waitcnt vmcnt(0)
  v_cmp_ne_u32 vcc, s70, v243
  s_cbranch_vccz L_ck_143
  s_mov_b32 s77, 0
L_poll_144:
  buffer_load_dword v243, v242, s[40:43], s76 offen sc1
  s_add_u32 s77, s77, 1
  s_waitcnt vmcnt(0)
  v_cmp_ne_u32 vcc, s70, v243
  s_cmp_ge_u32 s77, 400000
  s_cbranch_scc1 L_pdone_145
  s_cbranch_vccnz L_poll_144
L_pdone_145:
L_ck_143:
L_pc_142:
  s_waitcnt lgkmcnt(6)
  v_mfma_f32_16x16x32_bf16 v[128:131], v[184:187], v[56:59], v[128:131]
  v_mfma_f32_16x16x32_bf16 v[132:135], v[184:187], v[112:115], v[132:135]
  v_mfma_f32_16x16x32_bf16 v[136:139], v[188:191], v[56:59], v[136:139]
  v_mfma_f32_16x16x32_bf16 v[140:143], v[188:191], v[112:115], v[140:143]
  v_mfma_f32_16x16x32_bf16 v[144:147], v[192:195], v[56:59], v[144:147]
  v_mfma_f32_16x16x32_bf16 v[148:151], v[192:195], v[112:115], v[148:151]
  s_cmp_ge_u32 s5, 14
  s_cbranch_scc1 L_pc_146
  s_add_u32 s8, s90, 0
  buffer_load_dwordx4 v[16:19], v4, s[40:43], s8 offen sc1
  buffer_load_dwordx4 v[72:75], v6, s[40:43], s8 offen sc1
L_pc_146:
  ds_read_b128 v[184:187], v5 offset:5120
  ds_read_b128 v[188:191], v5 offset:19456
  ds_read_b128 v[192:195], v5 offset:33792
  s_waitcnt lgkmcnt(6)
  v_mfma_f32_16x16x32_bf16 v[128:131], v[226:229], v[60:63], v[128:131]
  v_mfma_f32_16x16x32_bf16 v[132:135], v[226:229], v[116:119], v[132:135]
  v_mfma_f32_16x16x32_bf16 v[136:139], v[230:233], v[60:63], v[136:139]
  v_mfma_f32_16x16x32_bf16 v[140:143], v[230:233], v[116:119], v[140:143]
  v_mfma_f32_16x16x32_bf16 v[144:147], v[234:237], v[60:63], v[144:147]
  v_mfma_f32_16x16x32_bf16 v[148:151], v[234:237], v[116:119], v[148:151]
  s_cmp_ge_u32 s5, 14
  s_cbranch_scc1 L_pc_147
  s_add_u32 s8, s90, 1024
  buffer_load_dwordx4 v[20:23], v4, s[40:43], s8 offen sc1
  buffer_load_dwordx4 v[76:79], v6, s[40:43], s8 offen sc1
L_pc_147:
  s_waitcnt lgkmcnt(3)
  v_mfma_f32_16x16x32_bf16 v[128:131], v[168:171], v[64:67], v[128:131]
  v_mfma_f32_16x16x32_bf16 v[132:135], v[168:171], v[120:123], v[132:135]
  v_mfma_f32_16x16x32_bf16 v[136:139], v[172:175], v[64:67], v[136:139]
  v_mfma_f32_16x16x32_bf16 v[140:143], v[172:175], v[120:123], v[140:143]
  v_mfma_f32_16x16x32_bf16 v[144:147], v[176:179], v[64:67], v[144:147]
  v_mfma_f32_16x16x32_bf16 v[148:151], v[176:179], v[120:123], v[148:151]
  s_cmp_ge_u32 s5, 14
  s_cbranch_scc1 L_pc_148
  s_add_u32 s8, s90, 2048
  buffer_load_dwordx4 v[24:27], v4, s[40:43], s8 offen sc1
  buffer_load_dwordx4 v[80:83], v6, s[40:43], s8 offen sc1
L_pc_148:
  s_waitcnt lgkmcnt(0)
  v_mfma_f32_16x16x32_bf16 v[128:131], v[184:187], v[68:71], v[128:131]
  v_mfma_f32_16x16x32_bf16 v[132:135], v[184:187], v[124:127], v[132:135]
  v_mfma_f32_16x16x32_bf16 v[136:139], v[188:191], v[68:71], v[136:139]
  v_mfma_f32_16x16x32_bf16 v[140:143], v[188:191], v[124:127], v[140:143]
  v_mfma_f32_16x16x32_bf16 v[144:147], v[192:195], v[68:71], v[144:147]
  v_mfma_f32_16x16x32_bf16 v[148:151], v[192:195], v[124:127], v[148:151]
  s_nop 7
  v_maximum3_f32 v128, v128, 0, 0
  v_maximum3_f32 v129, v129, 0, 0
  v_maximum3_f32 v130, v130, 0, 0
  v_maximum3_f32 v131, v131, 0, 0
  v_maximum3_f32 v132, v132, 0, 0
  v_maximum3_f32 v133, v133, 0, 0
  v_maximum3_f32 v134, v134, 0, 0
  v_maximum3_f32 v135, v135, 0, 0
  v_cvt_pk_bf16_f32 v128, v128, v129
  v_cvt_pk_bf16_f32 v129, v130, v131
  v_cvt_pk_bf16_f32 v130, v132, v133
  v_cvt_pk_bf16_f32 v131, v134, v135
  v_maximum3_f32 v136, v136, 0, 0
  v_maximum3_f32 v137, v137, 0, 0
  v_maximum3_f32 v138, v138, 0, 0
  v_maximum3_f32 v139, v139, 0, 0
  v_maximum3_f32 v140, v140, 0, 0
  v_maximum3_f32 v141, v141, 0, 0
  v_maximum3_f32 v142, v142, 0, 0
  v_maximum3_f32 v143, v143, 0, 0
  v_cvt_pk_bf16_f32 v136, v136, v137
  v_cvt_pk_bf16_f32 v137, v138, v139
  v_cvt_pk_bf16_f32 v138, v140, v141
  v_cvt_pk_bf16_f32 v139, v142, v143
  v_maximum3_f32 v144, v144, 0, 0
  v_maximum3_f32 v145, v145, 0, 0
  v_maximum3_f32 v146, v146, 0, 0
  v_maximum3_f32 v147, v147, 0, 0
  v_maximum3_f32 v148, v148, 0, 0
  v_maximum3_f32 v149, v149, 0, 0
  v_maximum3_f32 v150, v150, 0, 0
  v_maximum3_f32 v151, v151, 0, 0
  v_cvt_pk_bf16_f32 v144, v144, v145
  v_cvt_pk_bf16_f32 v145, v146, v147
  v_cvt_pk_bf16_f32 v146, v148, v149
  v_cvt_pk_bf16_f32 v147, v150, v151
  s_nop 1
  v_permlane16_swap_b32 v128, v130
  v_permlane16_swap_b32 v129, v131
  v_permlane16_swap_b32 v136, v138
  v_permlane16_swap_b32 v137, v139
  v_permlane16_swap_b32 v144, v146
  v_permlane16_swap_b32 v145, v147
  s_cmp_lg_u32 s65, 0
  s_cbranch_scc1 L_fast_149
  buffer_store_dwordx4 v[128:131], v4, s[40:43], s89 offen offset:0 sc1
  buffer_store_dwordx4 v[136:139], v4, s[40:43], s89 offen offset:1024 sc1
  buffer_store_dwordx4 v[144:147], v4, s[40:43], s89 offen offset:2048 sc1
  s_branch L_sdone_150
L_fast_149:
  buffer_store_dwordx4 v[128:131], v4, s[40:43], s89 offen offset:0
  buffer_store_dwordx4 v[136:139], v4, s[40:43], s89 offen offset:1024
  buffer_store_dwordx4 v[144:147], v4, s[40:43], s89 offen offset:2048
L_sdone_150:
  s_cmp_lt_u32 s5, 14
  s_cbranch_scc1 L_g2_151
  s_add_u32 s76, s71, 8192
  s_waitcnt vmcnt(0)
  s_cmp_lg_u32 s67, 0
  s_cbranch_scc1 L_fast_152
  buffer_store_dword v245, v246, s[40:43], s76 offen sc1
  s_branch L_sdone_153
L_fast_152:
  buffer_store_dword v245, v246, s[40:43], s76 offen
L_sdone_153:
  s_branch L_nog2_137
L_g2_151:
  s_add_u32 s8, s90, 3072
  buffer_load_dwordx4 v[28:31], v4, s[40:43], s8 offen sc1
  buffer_load_dwordx4 v[84:87], v6, s[40:43], s8 offen sc1
  s_add_u32 s8, s90, 7168
  buffer_load_dwordx4 v[32:35], v4, s[40:43], s8 offen sc1
  buffer_load_dwordx4 v[88:91], v6, s[40:43], s8 offen sc1
  s_add_u32 s8, s90, 8192
  buffer_load_dwordx4 v[36:39], v4, s[40:43], s8 offen sc1
  buffer_load_dwordx4 v[92:95], v6, s[40:43], s8 offen sc1
  s_waitcnt vmcnt(6)
  s_add_u32 s76, s71, 8192
  s_cmp_lg_u32 s67, 0
  s_cbranch_scc1 L_fast_154
  buffer_store_dword v245, v246, s[40:43], s76 offen sc1
  s_branch L_sdone_155
L_fast_154:
  buffer_store_dword v245, v246, s[40:43], s76 offen
L_sdone_155:
  s_add_u32 s8, s90, 9216
  buffer_load_dwordx4 v[40:43], v4, s[40:43], s8 offen sc1
  buffer_load_dwordx4 v[96:99], v6, s[40:43], s8 offen sc1
  v_mfma_f32_32x32x16_bf16 v[128:143], a[0:3], v[16:19], 0
  v_mfma_f32_32x32x16_bf16 v[144:159], a[0:3], v[72:75], 0
  v_mfma_f32_32x32x16_bf16 v[160:175], a[4:7], v[16:19], 0
  v_mfma_f32_32x32x16_bf16 v[176:191], a[4:7], v[72:75], 0
  s_add_u32 s8, s90, 10240
  buffer_load_dwordx4 v[44:47], v4, s[40:43], s8 offen sc1
  buffer_load_dwordx4 v[100:103], v6, s[40:43], s8 offen sc1
  v_mfma_f32_32x32x16_bf16 v[128:143], a[8:11], v[20:23], v[128:143]
  v_mfma_f32_32x32x16_bf16 v[144:159], a[8:11], v[76:79], v[144:159]
  v_mfma_f32_32x32x16_bf16 v[160:175], a[12:15], v[20:23], v[160:175]
  v_mfma_f32_32x32x16_bf16 v[176:191], a[12:15], v[76:79], v[176:191]
  s_add_u32 s8, s90, 14336
  buffer_load_dwordx4 v[48:51], v4, s[40:43], s8 offen sc1
  buffer_load_dwordx4 v[104:107], v6, s[40:43], s8 offen sc1
  v_mfma_f32_32x32x16_bf16 v[128:143], a[16:19], v[24:27], v[128:143]
  v_mfma_f32_32x32x16_bf16 v[144:159], a[16:19], v[80:83], v[144:159]
  v_mfma_f32_32x32x16_bf16 v[160:175], a[20:23], v[24:27], v[160:175]
  v_mfma_f32_32x32x16_bf16 v[176:191], a[20:23], v[80:83], v[176:191]
  s_add_u32 s8, s90, 15360
  buffer_load_dwordx4 v[52:55], v4, s[40:43], s8 offen sc1
  buffer_load_dwordx4 v[108:111], v6, s[40:43], s8 offen sc1
  s_waitcnt vmcnt(13)
  v_mfma_f32_32x32x16_bf16 v[128:143], a[24:27], v[28:31], v[128:143]
  v_mfma_f32_32x32x16_bf16 v[144:159], a[24:27], v[84:87], v[144:159]
  v_mfma_f32_32x32x16_bf16 v[160:175], a[28:31], v[28:31], v[160:175]
  v_mfma_f32_32x32x16_bf16 v[176:191], a[28:31], v[84:87], v[176:191]
  s_add_u32 s8, s90, 16384
  buffer_load_dwordx4 v[56:59], v4, s[40:43], s8 offen sc1
  buffer_load_dwordx4 v[112:115], v6, s[40:43], s8 offen sc1
  s_waitcnt vmcnt(13)
  v_mfma_f32_32x32x16_bf16 v[128:143], a[56:59], v[32:35], v[128:143]
  v_mfma_f32_32x32x16_bf16 v[144:159], a[56:59], v[88:91], v[144:159]
  v_mfma_f32_32x32x16_bf16 v[160:175], a[60:63], v[32:35], v[160:175]
  v_mfma_f32_32x32x16_bf16 v[176:191], a[60:63], v[88:91], v[176:191]
  s_add_u32 s8, s90, 17408
  buffer_load_dwordx4 v[60:63], v4, s[40:43], s8 offen sc1
  buffer_load_dwordx4 v[116:119], v6, s[40:43], s8 offen sc1
  s_waitcnt vmcnt(13)
  v_mfma_f32_32x32x16_bf16 v[128:143], a[64:67], v[36:39], v[128:143]
  v_mfma_f32_32x32x16_bf16 v[144:159], a[64:67], v[92:95], v[144:159]
  v_mfma_f32_32x32x16_bf16 v[160:175], a[68:71], v[36:39], v[160:175]
  v_mfma_f32_32x32x16_bf16 v[176:191], a[68:71], v[92:95], v[176:191]
  buffer_load_dword v243, v242, s[40:43], s76 offen sc1
  s_add_u32 s8, s90, 21504
  buffer_load_dwordx4 v[64:67], v4, s[40:43], s8 offen sc1
  buffer_load_dwordx4 v[120:123], v6, s[40:43], s8 offen sc1
  s_waitcnt vmcnt(13)
  v_mfma_f32_32x32x16_bf16 v[128:143], a[72:75], v[40:43], v[128:143]
  v_mfma_f32_32x32x16_bf16 v[144:159], a[72:75], v[96:99], v[144:159]
  v_mfma_f32_32x32x16_bf16 v[160:175], a[76:79], v[40:43], v[160:175]
  v_mfma_f32_32x32x16_bf16 v[176:191], a[76:79], v[96:99], v[176:191]
  s_add_u32 s8, s90, 22528
  buffer_load_dwordx4 v[68:71], v4, s[40:43], s8 offen sc1
  buffer_load_dwordx4 v[124:127], v6, s[40:43], s8 offen sc1
  s_waitcnt vmcnt(13)
  v_mfma_f32_32x32x16_bf16 v[128:143], a[80:83], v[44:47], v[128:143]
  v_mfma_f32_32x32x16_bf16 v[144:159], a[80:83], v[100:103], v[144:159]
  v_mfma_f32_32x32x16_bf16 v[160:175], a[84:87], v[44:47], v[160:175]
  v_mfma_f32_32x32x16_bf16 v[176:191], a[84:87], v[100:103], v[176:191]
  s_add_u32 s8, s90, 23552
  buffer_load_dwordx4 v[16:19], v4, s[40:43], s8 offen sc1
  buffer_load_dwordx4 v[72:75], v6, s[40:43], s8 offen sc1
  s_waitcnt vmcnt(13)
  v_mfma_f32_32x32x16_bf16 v[128:143], a[112:115], v[48:51], v[128:143]
  v_mfma_f32_32x32x16_bf16 v[144:159], a[112:115], v[104:107], v[144:159]
  v_mfma_f32_32x32x16_bf16 v[160:175], a[116:119], v[48:51], v[160:175]
  v_mfma_f32_32x32x16_bf16 v[176:191], a[116:119], v[104:107], v[176:191]
  s_add_u32 s8, s90, 24576
  buffer_load_dwordx4 v[20:23], v4, s[40:43], s8 offen sc1
  buffer_load_dwordx4 v[76:79], v6, s[40:43], s8 offen sc1
  s_waitcnt vmcnt(13)
  v_mfma_f32_32x32x16_bf16 v[128:143], a[120:123], v[52:55], v[128:143]
  v_mfma_f32_32x32x16_bf16 v[144:159], a[120:123], v[108:111], v[144:159]
  v_mfma_f32_32x32x16_bf16 v[160:175], a[124:127], v[52:55], v[160:175]
  v_mfma_f32_32x32x16_bf16 v[176:191], a[124:127], v[108:111], v[176:191]
  s_waitcnt vmcnt(8)
  v_cmp_ne_u32 vcc, s70, v243
  s_cbranch_vccz L_ck_156
  s_mov_b32 s77, 0
L_poll_157:
  buffer_load_dword v243, v242, s[40:43], s76 offen sc1
  s_add_u32 s77, s77, 1
  s_waitcnt vmcnt(0)
  v_cmp_ne_u32 vcc, s70, v243
  s_cmp_ge_u32 s77, 400000
  s_cbranch_scc1 L_pdone_158
  s_cbranch_vccnz L_poll_157
L_pdone_158:
L_ck_156:
  s_add_u32 s8, s90, 4096
  buffer_load_dwordx4 v[24:27], v4, s[40:43], s8 offen sc1
  buffer_load_dwordx4 v[80:83], v6, s[40:43], s8 offen sc1
  v_mfma_f32_32x32x16_bf16 v[128:143], a[128:131], v[56:59], v[128:143]
  v_mfma_f32_32x32x16_bf16 v[144:159], a[128:131], v[112:115], v[144:159]
  v_mfma_f32_32x32x16_bf16 v[160:175], a[132:135], v[56:59], v[160:175]
  v_mfma_f32_32x32x16_bf16 v[176:191], a[132:135], v[112:115], v[176:191]
  s_add_u32 s8, s90, 5120
  buffer_load_dwordx4 v[28:31], v4, s[40:43], s8 offen sc1
  buffer_load_dwordx4 v[84:87], v6, s[40:43], s8 offen sc1
  v_mfma_f32_32x32x16_bf16 v[128:143], a[136:139], v[60:63], v[128:143]
  v_mfma_f32_32x32x16_bf16 v[144:159], a[136:139], v[116:119], v[144:159]
  v_mfma_f32_32x32x16_bf16 v[160:175], a[140:143], v[60:63], v[160:175]
  v_mfma_f32_32x32x16_bf16 v[176:191], a[140:143], v[116:119], v[176:191]
  s_add_u32 s8, s90, 6144
  buffer_load_dwordx4 v[32:35], v4, s[40:43], s8 offen sc1
  buffer_load_dwordx4 v[88:91], v6, s[40:43], s8 offen sc1
  s_waitcnt vmcnt(12)
  v_mfma_f32_32x32x16_bf16 v[128:143], a[168:171], v[64:67], v[128:143]
  v_mfma_f32_32x32x16_bf16 v[144:159], a[168:171], v[120:123], v[144:159]
  v_mfma_f32_32x32x16_bf16 v[160:175], a[172:175], v[64:67], v[160:175]
  v_mfma_f32_32x32x16_bf16 v[176:191], a[172:175], v[120:123], v[176:191]
  s_add_u32 s8, s90, 11264
  buffer_load_dwordx4 v[36:39], v4, s[40:43], s8 offen sc1
  buffer_load_dwordx4 v[92:95], v6, s[40:43], s8 offen sc1
  s_waitcnt vmcnt(12)
  v_mfma_f32_32x32x16_bf16 v[128:143], a[176:179], v[68:71], v[128:143]
  v_mfma_f32_32x32x16_bf16 v[144:159], a[176:179], v[124:127], v[144:159]
  v_mfma_f32_32x32x16_bf16 v[160:175], a[180:183], v[68:71], v[160:175]
  v_mfma_f32_32x32x16_bf16 v[176:191], a[180:183], v[124:127], v[176:191]
  s_add_u32 s8, s90, 12288
  buffer_load_dwordx4 v[40:43], v4, s[40:43], s8 offen sc1
  buffer_load_dwordx4 v[96:99], v6, s[40:43], s8 offen sc1
  s_waitcnt vmcnt(12)
  v_mfma_f32_32x32x16_bf16 v[128:143], a[184:187], v[16:19], v[128:143]
  v_mfma_f32_32x32x16_bf16 v[144:159], a[184:187], v[72:75], v[144:159]
  v_mfma_f32_32x32x16_bf16 v[160:175], a[188:191], v[16:19], v[160:175]
  v_mfma_f32_32x32x16_bf16 v[176:191], a[188:191], v[72:75], v[176:191]
  s_add_u32 s8, s90, 13312
  buffer_load_dwordx4 v[44:47], v4, s[40:43], s8 offen sc1
  buffer_load_dwordx4 v[100:103], v6, s[40:43], s8 offen sc1
  s_waitcnt vmcnt(12)
  v_mfma_f32_32x32x16_bf16 v[128:143], a[192:195], v[20:23], v[128:143]
  v_mfma_f32_32x32x16_bf16 v[144:159], a[192:195], v[76:79], v[144:159]
  v_mfma_f32_32x32x16_bf16 v[160:175], a[196:199], v[20:23], v[160:175]
  v_mfma_f32_32x32x16_bf16 v[176:191], a[196:199], v[76:79], v[176:191]
  s_add_u32 s8, s90, 18432
  buffer_load_dwordx4 v[48:51], v4, s[40:43], s8 offen sc1
  buffer_load_dwordx4 v[104:107], v6, s[40:43], s8 offen sc1
  s_waitcnt vmcnt(12)
  v_mfma_f32_32x32x16_bf16 v[128:143], a[32:35], v[24:27], v[128:143]
  v_mfma_f32_32x32x16_bf16 v[144:159], a[32:35], v[80:83], v[144:159]
  v_mfma_f32_32x32x16_bf16 v[160:175], a[36:39], v[24:27], v[160:175]
  v_mfma_f32_32x32x16_bf16 v[176:191], a[36:39], v[80:83], v[176:191]
  s_add_u32 s8, s90, 19456
  buffer_load_dwordx4 v[52:55], v4, s[40:43], s8 offen sc1
  buffer_load_dwordx4 v[108:111], v6, s[40:43], s8 offen sc1
  s_waitcnt vmcnt(12)
  v_mfma_f32_32x32x16_bf16 v[128:143], a[40:43], v[28:31], v[128:143]
  v_mfma_f32_32x32x16_bf16 v[144:159], a[40:43], v[84:87], v[144:159]
  v_mfma_f32_32x32x16_bf16 v[160:175], a[44:47], v[28:31], v[160:175]
  v_mfma_f32_32x32x16_bf16 v[176:191], a[44:47], v[84:87], v[176:191]
  s_add_u32 s8, s90, 20480
  buffer_load_dwordx4 v[56:59], v4, s[40:43], s8 offen sc1
  buffer_load_dwordx4 v[112:115], v6, s[40:43], s8 offen sc1
  s_waitcnt vmcnt(12)
  v_mfma_f32_32x32x16_bf16 v[128:143], a[48:51], v[32:35], v[128:143]
  v_mfma_f32_32x32x16_bf16 v[144:159], a[48:51], v[88:91], v[144:159]
  v_mfma_f32_32x32x16_bf16 v[160:175], a[52:55], v[32:35], v[160:175]
  v_mfma_f32_32x32x16_bf16 v[176:191], a[52:55], v[88:91], v[176:191]
  s_add_u32 s8, s90, 25600
  buffer_load_dwordx4 v[60:63], v4, s[40:43], s8 offen sc1
  buffer_load_dwordx4 v[116:119], v6, s[40:43], s8 offen sc1
  s_waitcnt vmcnt(12)
  v_mfma_f32_32x32x16_bf16 v[128:143], a[88:91], v[36:39], v[128:143]
  v_mfma_f32_32x32x16_bf16 v[144:159], a[88:91], v[92:95], v[144:159]
  v_mfma_f32_32x32x16_bf16 v[160:175], a[92:95], v[36:39], v[160:175]
  v_mfma_f32_32x32x16_bf16 v[176:191], a[92:95], v[92:95], v[176:191]
  s_add_u32 s8, s90, 26624
  buffer_load_dwordx4 v[64:67], v4, s[40:43], s8 offen sc1
  buffer_load_dwordx4 v[120:123], v6, s[40:43], s8 offen sc1
  s_waitcnt vmcnt(12)
  v_mfma_f32_32x32x16_bf16 v[128:143], a[96:99], v[40:43], v[128:143]
  v_mfma_f32_32x32x16_bf16 v[144:159], a[96:99], v[96:99], v[144:159]
  v_mfma_f32_32x32x16_bf16 v[160:175], a[100:103], v[40:43], v[160:175]
  v_mfma_f32_32x32x16_bf16 v[176:191], a[100:103], v[96:99], v[176:191]
  s_add_u32 s8, s90, 27648
  buffer_load_dwordx4 v[68:71], v4, s[40:43], s8 offen sc1
  buffer_load_dwordx4 v[124:127], v6, s[40:43], s8 offen sc1
  s_waitcnt vmcnt(12)
  v_mfma_f32_32x32x16_bf16 v[128:143], a[104:107], v[44:47], v[128:143]
  v_mfma_f32_32x32x16_bf16 v[144:159], a[104:107], v[100:103], v[144:159]
  v_mfma_f32_32x32x16_bf16 v[160:175], a[108:111], v[44:47], v[160:175]
  v_mfma_f32_32x32x16_bf16 v[176:191], a[108:111], v[100:103], v[176:191]
  s_waitcnt vmcnt(10)
  v_mfma_f32_32x32x16_bf16 v[128:143], a[144:147], v[48:51], v[128:143]
  v_mfma_f32_32x32x16_bf16 v[144:159], a[144:147], v[104:107], v[144:159]
  v_mfma_f32_32x32x16_bf16 v[160:175], a[148:151], v[48:51], v[160:175]
  v_mfma_f32_32x32x16_bf16 v[176:191], a[148:151], v[104:107], v[176:191]
  s_waitcnt vmcnt(8)
  v_mfma_f32_32x32x16_bf16 v[128:143], a[152:155], v[52:55], v[128:143]
  v_mfma_f32_32x32x16_bf16 v[144:159], a[152:155], v[108:111], v[144:159]
  v_mfma_f32_32x32x16_bf16 v[160:175], a[156:159], v[52:55], v[160:175]
  v_mfma_f32_32x32x16_bf16 v[176:191], a[156:159], v[108:111], v[176:191]
  s_waitcnt vmcnt(6)
  v_mfma_f32_32x32x16_bf16 v[128:143], a[160:163], v[56:59], v[128:143]
  v_mfma_f32_32x32x16_bf16 v[144:159], a[160:163], v[112:115], v[144:159]
  v_mfma_f32_32x32x16_bf16 v[160:175], a[164:167], v[56:59], v[160:175]
  v_mfma_f32_32x32x16_bf16 v[176:191], a[164:167], v[112:115], v[176:191]
  s_waitcnt vmcnt(4)
  v_mfma_f32_32x32x16_bf16 v[128:143], a[200:203], v[60:63], v[128:143]
  v_mfma_f32_32x32x16_bf16 v[144:159], a[200:203], v[116:119], v[144:159]
  v_mfma_f32_32x32x16_bf16 v[160:175], a[204:207], v[60:63], v[160:175]
  v_mfma_f32_32x32x16_bf16 v[176:191], a[204:207], v[116:119], v[176:191]
  s_waitcnt vmcnt(2)
  v_mfma_f32_32x32x16_bf16 v[128:143], a[208:211], v[64:67], v[128:143]
  v_mfma_f32_32x32x16_bf16 v[144:159], a[208:211], v[120:123], v[144:159]
  v_mfma_f32_32x32x16_bf16 v[160:175], a[212:215], v[64:67], v[160:175]
  v_mfma_f32_32x32x16_bf16 v[176:191], a[212:215], v[120:123], v[176:191]
  s_waitcnt vmcnt(0)
  v_mfma_f32_32x32x16_bf16 v[128:143], a[216:219], v[68:71], v[128:143]
  v_mfma_f32_32x32x16_bf16 v[144:159], a[216:219], v[124:127], v[144:159]
  v_mfma_f32_32x32x16_bf16 v[160:175], a[220:223], v[68:71], v[160:175]
  v_mfma_f32_32x32x16_bf16 v[176:191], a[220:223], v[124:127], v[176:191]
  s_lshr_b32 s10, s3, 1
  s_and_b32 s11, s3, 1
  s_add_u32 s8, s13, s11
  s_lshl_b32 s8, s8, 5
  s_mul_i32 s8, s8, 896
  s_lshl_b32 s7, s14, 7
  s_add_u32 s8, s8, s7
  s_lshl_b32 s10, s10, 6
  s_add_u32 s8, s8, s10
  v_and_b32 v8, 31, v0
  v_mul_u32_u24 v8, 896, v8
  v_lshrrev_b32 v9, 5, v0
  v_lshl_add_u32 v8, v9, 4, v8
  s_add_u32 s9, s8, 12582912
  s_cmp_eq_u32 s95, 0
  s_cselect_b32 s9, 0x7ffffff0, s9
  buffer_load_dwordx4 v[16:19], v8, s[40:43], s9 offen sc1
  buffer_load_dwordx4 v[20:23], v8, s[40:43], s9 offen offset:32 sc1
  v_add_u32 v7, 100352, v4
  s_nop 7
  s_cmp_eq_u32 s3, 1
  s_cbranch_scc1 L_g2w_161
  s_cmp_eq_u32 s3, 2
  s_cbranch_scc1 L_g2w_162
  s_cmp_eq_u32 s3, 3
  s_cbranch_scc1 L_g2w_163
L_g2w_160:
  ds_write_b128 v7, v[144:147] offset:20480
  ds_write_b128 v7, v[148:151] offset:21504
  ds_write_b128 v7, v[152:155] offset:22528
  ds_write_b128 v7, v[156:159] offset:23552
  ds_write_b128 v7, v[160:163] offset:28672
  ds_write_b128 v7, v[164:167] offset:29696
  ds_write_b128 v7, v[168:171] offset:30720
  ds_write_b128 v7, v[172:175] offset:31744
  ds_write_b128 v7, v[176:179] offset:36864
  ds_write_b128 v7, v[180:183] offset:37888
  ds_write_b128 v7, v[184:187] offset:38912
  ds_write_b128 v7, v[188:191] offset:39936
  v_mov_b64 v[32:33], v[128:129]
  v_mov_b64 v[34:35], v[130:131]
  v_mov_b64 v[36:37], v[132:133]
  v_mov_b64 v[38:39], v[134:135]
  v_mov_b64 v[40:41], v[136:137]
  v_mov_b64 v[42:43], v[138:139]
  v_mov_b64 v[44:45], v[140:141]
  v_mov_b64 v[46:47], v[142:143]
  s_branch L_g2d_159
L_g2w_161:
  ds_write_b128 v7, v[128:131] offset:0
  ds_write_b128 v7, v[132:135] offset:1024
  ds_write_b128 v7, v[136:139] offset:2048
  ds_write_b128 v7, v[140:143] offset:3072
  ds_write_b128 v7, v[160:163] offset:32768
  ds_write_b128 v7, v[164:167] offset:33792
  ds_write_b128 v7, v[168:171] offset:34816
  ds_write_b128 v7, v[172:175] offset:35840
  ds_write_b128 v7, v[176:179] offset:40960
  ds_write_b128 v7, v[180:183] offset:41984
  ds_write_b128 v7, v[184:187] offset:43008
  ds_write_b128 v7, v[188:191] offset:44032
  v_mov_b64 v[32:33], v[144:145]
  v_mov_b64 v[34:35], v[146:147]
  v_mov_b64 v[36:37], v[148:149]
  v_mov_b64 v[38:39], v[150:151]
  v_mov_b64 v[40:41], v[152:153]
  v_mov_b64 v[42:43], v[154:155]
  v_mov_b64 v[44:45], v[156:157]
  v_mov_b64 v[46:47], v[158:159]
  s_branch L_g2d_159
L_g2w_162:
  ds_write_b128 v7, v[128:131] offset:4096
  ds_write_b128 v7, v[132:135] offset:5120
  ds_write_b128 v7, v[136:139] offset:6144
  ds_write_b128 v7, v[140:143] offset:7168
  ds_write_b128 v7, v[144:147] offset:12288
  ds_write_b128 v7, v[148:151] offset:13312
  ds_write_b128 v7, v[152:155] offset:14336
  ds_write_b128 v7, v[156:159] offset:15360
  ds_write_b128 v7, v[176:179] offset:45056
  ds_write_b128 v7, v[180:183] offset:46080
  ds_write_b128 v7, v[184:187] offset:47104
  ds_write_b128 v7, v[188:191] offset:48128
  v_mov_b64 v[32:33], v[160:161]
  v_mov_b64 v[34:35], v[162:163]
  v_mov_b64 v[36:37], v[164:165]
  v_mov_b64 v[38:39], v[166:167]
  v_mov_b64 v[40:41], v[168:169]
  v_mov_b64 v[42:43], v[170:171]
  v_mov_b64 v[44:45], v[172:173]
  v_mov_b64 v[46:47], v[174:175]
  s_branch L_g2d_159
L_g2w_163:
  ds_write_b128 v7, v[128:131] offset:8192
  ds_write_b128 v7, v[132:135] offset:9216
  ds_write_b128 v7, v[136:139] offset:10240
  ds_write_b128 v7, v[140:143] offset:11264
  ds_write_b128 v7, v[144:147] offset:16384
  ds_write_b128 v7, v[148:151] offset:17408
  ds_write_b128 v7, v[152:155] offset:18432
  ds_write_b128 v7, v[156:159] offset:19456
  ds_write_b128 v7, v[160:163] offset:24576
  ds_write_b128 v7, v[164:167] offset:25600
  ds_write_b128 v7, v[168:171] offset:26624
  ds_write_b128 v7, v[172:175] offset:27648
  v_mov_b64 v[32:33], v[176:177]
  v_mov_b64 v[34:35], v[178:179]
  v_mov_b64 v[36:37], v[180:181]
  v_mov_b64 v[38:39], v[182:183]
  v_mov_b64 v[40:41], v[184:185]
  v_mov_b64 v[42:43], v[186:187]
  v_mov_b64 v[44:45], v[188:189]
  v_mov_b64 v[46:47], v[190:191]
L_g2d_159:
  s_mul_i32 s10, s3, 12288
  v_add_u32 v7, s10, v7
  s_waitcnt lgkmcnt(0)
  s_barrier
  ds_read_b128 v[48:51], v7 offset:0
  ds_read_b128 v[52:55], v7 offset:1024
  ds_read_b128 v[56:59], v7 offset:2048
  ds_read_b128 v[60:63], v7 offset:3072
  ds_read_b128 v[64:67], v7 offset:4096
  ds_read_b128 v[68:71], v7 offset:5120
  ds_read_b128 v[72:75], v7 offset:6144
  ds_read_b128 v[76:79], v7 offset:7168
  ds_read_b128 v[80:83], v7 offset:8192
  ds_read_b128 v[84:87], v7 offset:9216
  ds_read_b128 v[88:91], v7 offset:10240
  ds_read_b128 v[92:95], v7 offset:11264
  s_waitcnt lgkmcnt(8)
  v_pk_add_f32 v[32:33], v[32:33], v[48:49]
  v_pk_add_f32 v[34:35], v[34:35], v[50:51]
  v_pk_add_f32 v[36:37], v[36:37], v[52:53]
  v_pk_add_f32 v[38:39], v[38:39], v[54:55]
  v_pk_add_f32 v[40:41], v[40:41], v[56:57]
  v_pk_add_f32 v[42:43], v[42:43], v[58:59]
  v_pk_add_f32 v[44:45], v[44:45], v[60:61]
  v_pk_add_f32 v[46:47], v[46:47], v[62:63]
  s_waitcnt lgkmcnt(4)
  v_pk_add_f32 v[32:33], v[32:33], v[64:65]
  v_pk_add_f32 v[34:35], v[34:35], v[66:67]
  v_pk_add_f32 v[36:37], v[36:37], v[68:69]
  v_pk_add_f32 v[38:39], v[38:39], v[70:71]
  v_pk_add_f32 v[40:41], v[40:41], v[72:73]
  v_pk_add_f32 v[42:43], v[42:43], v[74:75]
  v_pk_add_f32 v[44:45], v[44:45], v[76:77]
  v_pk_add_f32 v[46:47], v[46:47], v[78:79]
  s_waitcnt lgkmcnt(0)
  v_pk_add_f32 v[32:33], v[32:33], v[80:81]
  v_pk_add_f32 v[34:35], v[34:35], v[82:83]
  v_pk_add_f32 v[36:37], v[36:37], v[84:85]
  v_pk_add_f32 v[38:39], v[38:39], v[86:87]
  v_pk_add_f32 v[40:41], v[40:41], v[88:89]
  v_pk_add_f32 v[42:43], v[42:43], v[90:91]
  v_pk_add_f32 v[44:45], v[44:45], v[92:93]
  v_pk_add_f32 v[46:47], v[46:47], v[94:95]
  v_cvt_pk_bf16_f32 v24, v32, v33
  v_cvt_pk_bf16_f32 v25, v34, v35
  v_cvt_pk_bf16_f32 v26, v36, v37
  v_cvt_pk_bf16_f32 v27, v38, v39
  v_cvt_pk_bf16_f32 v28, v40, v41
  v_cvt_pk_bf16_f32 v29, v42, v43
  v_cvt_pk_bf16_f32 v30, v44, v45
  v_cvt_pk_bf16_f32 v31, v46, v47
  s_nop 1
  v_permlane32_swap_b32 v24, v26
  v_permlane32_swap_b32 v25, v27
  v_permlane32_swap_b32 v28, v30
  v_permlane32_swap_b32 v29, v31
  s_cmp_eq_u32 s95, 0
  s_cbranch_scc1 L_g2l0_164
  s_mov_b32 s44, s34
  s_mov_b32 s45, s35
  s_mov_b32 s46, 0x1c0000
  s_mov_b32 s47, 0x20000
  s_waitcnt vmcnt(0)
  v_lshlrev_b32 v32, 16, v24
  v_and_b32 v33, s12, v24
  v_lshlrev_b32 v34, 16, v25
  v_and_b32 v35, s12, v25
  v_lshlrev_b32 v36, 16, v26
  v_and_b32 v37, s12, v26
  v_lshlrev_b32 v38, 16, v27
  v_and_b32 v39, s12, v27
  v_lshlrev_b32 v40, 16, v28
  v_and_b32 v41, s12, v28
  v_lshlrev_b32 v42, 16, v29
  v_and_b32 v43, s12, v29
  v_lshlrev_b32 v44, 16, v30
  v_and_b32 v45, s12, v30
  v_lshlrev_b32 v46, 16, v31
  v_and_b32 v47, s12, v31
  v_lshlrev_b32 v48, 16, v16
  v_and_b32 v49, s12, v16
  v_lshlrev_b32 v50, 16, v17
  v_and_b32 v51, s12, v17
  v_lshlrev_b32 v52, 16, v18
  v_and_b32 v53, s12, v18
  v_lshlrev_b32 v54, 16, v19
  v_and_b32 v55, s12, v19
  v_lshlrev_b32 v56, 16, v20
  v_and_b32 v57, s12, v20
  v_lshlrev_b32 v58, 16, v21
  v_and_b32 v59, s12, v21
  v_lshlrev_b32 v60, 16, v22
  v_and_b32 v61, s12, v22
  v_lshlrev_b32 v62, 16, v23
  v_and_b32 v63, s12, v23
  v_pk_add_f32 v[32:33], v[32:33], v[48:49]
  v_cvt_pk_bf16_f32 v24, v32, v33
  v_pk_add_f32 v[34:35], v[34:35], v[50:51]
  v_cvt_pk_bf16_f32 v25, v34, v35
  v_pk_add_f32 v[36:37], v[36:37], v[52:53]
  v_cvt_pk_bf16_f32 v26, v36, v37
  v_pk_add_f32 v[38:39], v[38:39], v[54:55]
  v_cvt_pk_bf16_f32 v27, v38, v39
  v_pk_add_f32 v[40:41], v[40:41], v[56:57]
  v_cvt_pk_bf16_f32 v28, v40, v41
  v_pk_add_f32 v[42:43], v[42:43], v[58:59]
  v_cvt_pk_bf16_f32 v29, v42, v43
  v_pk_add_f32 v[44:45], v[44:45], v[60:61]
  v_cvt_pk_bf16_f32 v30, v44, v45
  v_pk_add_f32 v[46:47], v[46:47], v[62:63]
  v_cvt_pk_bf16_f32 v31, v46, v47
  buffer_store_dwordx4 v[24:27], v8, s[44:47], s8 offen
  buffer_store_dwordx4 v[28:31], v8, s[44:47], s8 offen offset:32
  s_branch L_nog2_137
L_g2l0_164:
  s_add_u32 s8, s8, 12582912
  s_cmp_lg_u32 s67, 0
  s_cbranch_scc1 L_fast_165
  buffer_store_dwordx4 v[24:27], v8, s[40:43], s8 offen sc1
  buffer_store_dwordx4 v[28:31], v8, s[40:43], s8 offen offset:32 sc1
  s_branch L_sdone_166
L_fast_165:
  buffer_store_dwordx4 v[24:27], v8, s[40:43], s8 offen
  buffer_store_dwordx4 v[28:31], v8, s[40:43], s8 offen offset:32
L_sdone_166:
  s_add_u32 s76, s71, 12288
  s_waitcnt vmcnt(0)
  s_cmp_lg_u32 s67, 0
  s_cbranch_scc1 L_fast_167
  buffer_store_dword v245, v246, s[40:43], s76 offen sc1
  s_branch L_sdone_168
L_fast_167:
  buffer_store_dword v245, v246, s[40:43], s76 offen
L_sdone_168:
L_nog2_137:
L_end:
  s_endpgm

.section .rodata,"a"
.p2align 6
.amdhsa_kernel interleave_layers__ssm_conv_h3__dense_activation_relu__prompt_kernel
  .amdhsa_next_free_vgpr 512
  .amdhsa_next_free_sgpr 96
  .amdhsa_accum_offset 256
  .amdhsa_group_segment_fixed_size 0
  .amdhsa_kernarg_size 96
  .amdhsa_user_sgpr_count 2
  .amdhsa_user_sgpr_kernarg_segment_ptr 1
  .amdhsa_system_sgpr_workgroup_id_x 1
.end_amdhsa_kernel
```
